```python
import torch

def _softmax(x, axis=-1):
    return torch.softmax(x, dim=axis)
def _gelu(x):
    return torch.nn.functional.gelu(x, approximate="tanh")
def _silu(x):
    return torch.nn.functional.silu(x)
def _sigmoid(x):
    return torch.sigmoid(x)
def _layernorm(x, axis=-1, eps=1e-5):
    m = x.mean(dim=axis, keepdim=True)
    v = x.var(dim=axis, keepdim=True, unbiased=False)
    return (x - m) / torch.sqrt(v + eps)
def _scatter_add(tgt, idx, src, axis=0):
    return tgt.clone().index_add_(axis, idx, src)
def _segment_sum(src, seg, n):
    out = torch.zeros((n,) + src.shape[1:], dtype=src.dtype)
    return out.index_add_(0, seg, src)
def _pad(x, pw):
    flat = tuple(v for pair in reversed(pw) for v in pair)
    return torch.nn.functional.pad(x, flat)

kernel_name = 'concat_heads__linear_attn_block__sliding_block__prompt'

def setup_inputs():

    _w = (lambda a: (lambda t: t.to(torch.bfloat16) if t.is_floating_point() else t)(torch.as_tensor(a)))
    def _A_setup():
        B, S, D = 1, 2048, 640
        return {
            "x": _w((lambda *s: torch.randn(*s, dtype=torch.bfloat16) * 0.05)(B, S, D)),
            "wqkv": _w((lambda *s: torch.randn(*s, dtype=torch.bfloat16) * 1.6)(D, 3 * D)),
            "wo": _w((lambda *s: torch.randn(*s, dtype=torch.bfloat16) * 0.8)(D, D)),
        }
    _A_in = _A_setup()

    def _B_setup():
        B, S, D = 1, 2048, 640
        return {
            "x": _w((lambda *s: torch.randn(*s, dtype=torch.bfloat16) * 0.2)(B, S, D)),
            "wqkv": _w((lambda *s: torch.randn(*s, dtype=torch.bfloat16) * 0.2)(D, 3 * D)),
            "wo": _w((lambda *s: torch.randn(*s, dtype=torch.bfloat16) * 0.05)(D, D)),
        }
    _B_in = _B_setup()

    return {
        "A_x": _A_in["x"],
        "A_wqkv": _A_in["wqkv"],
        "A_wo": _A_in["wo"],
        "B_x": _B_in["x"],
        "B_wqkv": _B_in["wqkv"],
        "B_wo": _B_in["wo"],
    }

def reference(A_x, A_wqkv, A_wo, B_x, B_wqkv, B_wo):
    def _A_ref(x, wqkv, wo):
        B, S, D = x.shape
        H = 32; Dh = D // H
        qkv = (lambda x, *d: x.permute(*d))((x @ wqkv).reshape(B, S, 3, H, Dh), 2, 0, 3, 1, 4)
        q, k, v = qkv[0], qkv[1], qkv[2]
        phi = lambda t: torch.where(t > 0, t + 1, torch.exp(t)) + 1e-6
        pq, pk = phi(q), phi(k)
        kv = torch.einsum("bhsd,bhse->bhde", pk, v)
        z = torch.einsum("bhsd->bhd", pk)
        num = torch.einsum("bhqd,bhde->bhqe", pq, kv)
        den = torch.einsum("bhqd,bhd->bhq", pq, z)[..., None] + 1e-6
        o = num / den
        return (lambda x, *d: x.permute(*d))(o, 0, 2, 1, 3).reshape(B, S, D) @ wo

    def _B_ref(x, wqkv, wo):
        B, S, D = x.shape
        H = 32; Dh = D // H; W = 256
        qkv = (lambda x, *d: x.permute(*d))((x @ wqkv).reshape(B, S, 3, H, Dh), 2, 0, 3, 1, 4)
        q, k, v = qkv[0], qkv[1], qkv[2]
        scores = torch.einsum("bhqd,bhkd->bhqk", q, k) * (Dh ** -0.5)
        idx = torch.arange(S)
        mask = (idx[:, None] - idx[None, :] >= 0) & (idx[:, None] - idx[None, :] < W)
        scores = torch.where(mask[None, None], scores, -1e9)
        p = _softmax(scores, axis=-1)
        o = torch.einsum("bhqk,bhkd->bhqd", p, v)
        return (lambda x, *d: x.permute(*d))(o, 0, 2, 1, 3).reshape(B, S, D) @ wo

    a = _A_ref(A_x, A_wqkv, A_wo)
    b = _B_ref(B_x, B_wqkv, B_wo)
    return torch.concatenate([a, b], axis=-1)
```

```asm
; @launch grid=(256,1,1) block=(512,1,1) lds=157760
.amdgcn_target "amdgcn-amd-amdhsa--gfx950"
.text
.globl concat_heads__linear_attn_block__sliding_block__prompt_kernel
.p2align 8
.type concat_heads__linear_attn_block__sliding_block__prompt_kernel,@function
concat_heads__linear_attn_block__sliding_block__prompt_kernel:
    s_cmp_ge_u32 s2, 256
    s_cbranch_scc1 concat_heads__linear_attn_block__sliding_block__prompt_kernel_end
    s_load_dwordx4 s[4:7], s[0:1], 56
    s_load_dwordx4 s[36:39], s[0:1], 0
    s_load_dwordx4 s[40:43], s[0:1], 24
    v_lshrrev_b32 v1, 6, v0
    s_nop 0
    v_readfirstlane_b32 s3, v1
    s_lshr_b32 s18, s2, 3
    s_nop 1
    s_cmp_lg_u32 s3, 1
    s_cbranch_scc1 concat_heads__linear_attn_block__sliding_block__prompt_kernel_nocpf
    s_getpc_b64 s[24:25]
concat_heads__linear_attn_block__sliding_block__prompt_kernel_cpfpc:
    s_sub_u32 s24, s24, (concat_heads__linear_attn_block__sliding_block__prompt_kernel_cpfpc - concat_heads__linear_attn_block__sliding_block__prompt_kernel)
    s_subb_u32 s25, s25, 0
    s_and_b32 s25, s25, 0xffff
    s_mov_b32 s26, (concat_heads__linear_attn_block__sliding_block__prompt_kernel_end - concat_heads__linear_attn_block__sliding_block__prompt_kernel)
    s_mov_b32 s27, 0x20000
    v_mbcnt_lo_u32_b32 v5, -1, 0
    v_mbcnt_hi_u32_b32 v5, -1, v5
    s_and_b32 s18, s18, 3
    s_lshl_b32 s18, s18, 6
    v_add_u32 v5, s18, v5
    v_lshlrev_b32 v5, 7, v5
    buffer_load_dword v199, v5, s[24:27], 0 offen
concat_heads__linear_attn_block__sliding_block__prompt_kernel_nocpf:
    s_and_b32 s70, s2, 7
    s_lshr_b32 s71, s2, 3
    s_lshr_b32 s44, s70, 2
    s_and_b32 s18, s70, 3
    s_mul_i32 s18, s18, 30
    s_add_u32 s18, s18, s71
    s_cmp_ge_u32 s18, 60
    s_cselect_b32 s19, 4, 0
    s_cselect_b32 s20, 60, 0
    s_sub_u32 s18, s18, s20
    s_lshr_b32 s46, s18, 2
    s_and_b32 s18, s18, 3
    s_add_u32 s45, s19, s18
    s_cmp_ge_u32 s46, 5
    s_cselect_b32 s47, 1, 0
    s_cmp_ge_u32 s46, 10
    s_cselect_b32 s47, 2, s47
    s_mul_i32 s18, s47, 5
    s_sub_u32 s48, s46, s18
    s_and_b32 s49, s3, 3
    s_lshr_b32 s50, s49, 1
    s_and_b32 s51, s49, 1
    s_waitcnt lgkmcnt(0)
    s_mov_b32 s8, s6
    s_and_b32 s9, s7, 0xffff
    s_mov_b32 s10, 0x16a0000
    s_mov_b32 s11, 0x20000
    s_mov_b32 s12, s4
    s_and_b32 s13, s5, 0xffff
    s_mov_b32 s14, 0x100
    s_mov_b32 s15, 0x20000
    s_cmp_ge_u32 s3, 4
    s_cbranch_scc1 concat_heads__linear_attn_block__sliding_block__prompt_kernel_p1h
    s_or_b32 s18, s2, s3
    s_cmp_lg_u32 s18, 0
    s_cbranch_scc1 concat_heads__linear_attn_block__sliding_block__prompt_kernel_nonon
    s_memrealtime s[16:17]
    s_waitcnt lgkmcnt(0)
    s_or_b32 s16, s16, 1
    v_mov_b32 v2, s16
    v_mov_b32 v3, s17
    v_mov_b32 v4, 0
    s_mov_b64 exec, 1
    buffer_store_dwordx2 v[2:3], v4, s[12:15], 0 offen sc1
    s_mov_b64 exec, -1
concat_heads__linear_attn_block__sliding_block__prompt_kernel_nonon:
    s_cmp_lg_u32 s3, 0
    s_cbranch_scc1 concat_heads__linear_attn_block__sliding_block__prompt_kernel_noinit
    v_mbcnt_lo_u32_b32 v5, -1, 0
    v_mbcnt_hi_u32_b32 v5, -1, v5
    v_lshlrev_b32 v5, 2, v5
    v_add_u32 v5, 0x26800, v5
    v_mov_b32 v6, 0
    s_mov_b32 exec_lo, 0xffff
    s_mov_b32 exec_hi, 0
    ds_write_b32 v5, v6
    s_mov_b64 exec, -1
    s_waitcnt lgkmcnt(0)
    v_mbcnt_lo_u32_b32 v5, -1, 0
    v_mbcnt_hi_u32_b32 v5, -1, v5
    s_lshl_b32 s18, s70, 2
    s_and_b32 s19, s71, 3
    s_add_u32 s18, s18, s19
    s_lshl_b32 s18, s18, 7
    s_add_u32 s18, s18, 23658496
    s_lshr_b32 s19, s70, 2
    s_lshl_b32 s19, s19, 3
    s_and_b32 s20, s70, 3
    s_lshl_b32 s20, s20, 1
    s_lshr_b32 s21, s71, 4
    s_add_u32 s20, s20, s21
    s_add_u32 s19, s19, s20
    s_lshl_b32 s19, s19, 8
    s_and_b32 s20, s71, 7
    s_lshl_b32 s20, s20, 12
    s_add_u32 s19, s19, s20
    s_add_u32 s19, s19, 23666560
    v_lshlrev_b32 v6, 3, v5
    v_add_u32 v7, s18, v6
    v_add_u32 v6, s19, v6
    v_cmp_gt_u32 vcc, 16, v5
    s_nop 1
    v_cndmask_b32 v6, v6, v7, vcc
    s_mov_b32 exec_lo, -1
    s_mov_b32 exec_hi, 0xffff
    buffer_load_dword v199, v6, s[8:11], 0 offen sc1
    s_mov_b64 exec, -1
concat_heads__linear_attn_block__sliding_block__prompt_kernel_noinit:
    s_cmp_ge_u32 s71, 30
    s_cbranch_scc1 concat_heads__linear_attn_block__sliding_block__prompt_kernel_p2c
    v_mbcnt_lo_u32_b32 v194, -1, 0
    v_mbcnt_hi_u32_b32 v194, -1, v194
    v_and_b32 v195, 31, v194
    s_lshl_b32 s18, s50, 7
    v_add_u32 v196, s18, v195
    v_lshlrev_b32 v196, 7, v196
    v_bfe_u32 v195, v195, 1, 3
    v_lshrrev_b32 v197, 5, v194
    v_add_u32 v200, 0, v197
    v_xor_b32 v200, v200, v195
    v_lshl_add_u32 v176, v200, 4, v196
    v_add_u32 v200, 2, v197
    v_xor_b32 v200, v200, v195
    v_lshl_add_u32 v177, v200, 4, v196
    v_add_u32 v200, 4, v197
    v_xor_b32 v200, v200, v195
    v_lshl_add_u32 v178, v200, 4, v196
    v_add_u32 v200, 6, v197
    v_xor_b32 v200, v200, v195
    v_lshl_add_u32 v179, v200, 4, v196
    v_bfe_u32 v195, v194, 2, 2
    v_lshrrev_b32 v196, 5, v194
    v_lshl_add_u32 v196, v196, 3, v195
    v_lshlrev_b32 v196, 8, v196
    v_add_u32 v196, 32768, v196
    v_and_b32 v197, 1, v194
    v_lshl_add_u32 v196, v197, 3, v196
    v_bfe_u32 v197, v194, 4, 1
    v_lshlrev_b32 v197, 1, v197
    v_bfe_u32 v200, v194, 1, 1
    v_add_u32 v197, v197, v200
    s_lshl_b32 s18, s51, 3
    v_add_u32 v197, s18, v197
    v_lshlrev_b32 v195, 2, v195
    v_add_u32 v200, 0, v197
    v_xor_b32 v200, v200, v195
    v_lshl_add_u32 v180, v200, 4, v196
    v_add_u32 v200, 4, v197
    v_xor_b32 v200, v200, v195
    v_lshl_add_u32 v181, v200, 4, v196
    v_mov_b32 v0, 0
    v_mov_b32 v1, 0
    v_mov_b32 v2, 0
    v_mov_b32 v3, 0
    v_mov_b32 v4, 0
    v_mov_b32 v5, 0
    v_mov_b32 v6, 0
    v_mov_b32 v7, 0
    v_mov_b32 v8, 0
    v_mov_b32 v9, 0
    v_mov_b32 v10, 0
    v_mov_b32 v11, 0
    v_mov_b32 v12, 0
    v_mov_b32 v13, 0
    v_mov_b32 v14, 0
    v_mov_b32 v15, 0
    v_mov_b32 v16, 0
    v_mov_b32 v17, 0
    v_mov_b32 v18, 0
    v_mov_b32 v19, 0
    v_mov_b32 v20, 0
    v_mov_b32 v21, 0
    v_mov_b32 v22, 0
    v_mov_b32 v23, 0
    v_mov_b32 v24, 0
    v_mov_b32 v25, 0
    v_mov_b32 v26, 0
    v_mov_b32 v27, 0
    v_mov_b32 v28, 0
    v_mov_b32 v29, 0
    v_mov_b32 v30, 0
    v_mov_b32 v31, 0
    v_mov_b32 v32, 0
    v_mov_b32 v33, 0
    v_mov_b32 v34, 0
    v_mov_b32 v35, 0
    v_mov_b32 v36, 0
    v_mov_b32 v37, 0
    v_mov_b32 v38, 0
    v_mov_b32 v39, 0
    v_mov_b32 v40, 0
    v_mov_b32 v41, 0
    v_mov_b32 v42, 0
    v_mov_b32 v43, 0
    v_mov_b32 v44, 0
    v_mov_b32 v45, 0
    v_mov_b32 v46, 0
    v_mov_b32 v47, 0
    v_mov_b32 v48, 0
    v_mov_b32 v49, 0
    v_mov_b32 v50, 0
    v_mov_b32 v51, 0
    v_mov_b32 v52, 0
    v_mov_b32 v53, 0
    v_mov_b32 v54, 0
    v_mov_b32 v55, 0
    v_mov_b32 v56, 0
    v_mov_b32 v57, 0
    v_mov_b32 v58, 0
    v_mov_b32 v59, 0
    v_mov_b32 v60, 0
    v_mov_b32 v61, 0
    v_mov_b32 v62, 0
    v_mov_b32 v63, 0
    v_mov_b32 v64, 0
    v_mov_b32 v65, 0
    v_mov_b32 v66, 0
    v_mov_b32 v67, 0
    v_mov_b32 v68, 0
    v_mov_b32 v69, 0
    v_mov_b32 v70, 0
    v_mov_b32 v71, 0
    v_mov_b32 v72, 0
    v_mov_b32 v73, 0
    v_mov_b32 v74, 0
    v_mov_b32 v75, 0
    v_mov_b32 v76, 0
    v_mov_b32 v77, 0
    v_mov_b32 v78, 0
    v_mov_b32 v79, 0
    v_mov_b32 v80, 0
    v_mov_b32 v81, 0
    v_mov_b32 v82, 0
    v_mov_b32 v83, 0
    v_mov_b32 v84, 0
    v_mov_b32 v85, 0
    v_mov_b32 v86, 0
    v_mov_b32 v87, 0
    v_mov_b32 v88, 0
    v_mov_b32 v89, 0
    v_mov_b32 v90, 0
    v_mov_b32 v91, 0
    v_mov_b32 v92, 0
    v_mov_b32 v93, 0
    v_mov_b32 v94, 0
    v_mov_b32 v95, 0
    v_mov_b32 v96, 0
    v_mov_b32 v97, 0
    v_mov_b32 v98, 0
    v_mov_b32 v99, 0
    v_mov_b32 v100, 0
    v_mov_b32 v101, 0
    v_mov_b32 v102, 0
    v_mov_b32 v103, 0
    v_mov_b32 v104, 0
    v_mov_b32 v105, 0
    v_mov_b32 v106, 0
    v_mov_b32 v107, 0
    v_mov_b32 v108, 0
    v_mov_b32 v109, 0
    v_mov_b32 v110, 0
    v_mov_b32 v111, 0
    v_mov_b32 v112, 0
    v_mov_b32 v113, 0
    v_mov_b32 v114, 0
    v_mov_b32 v115, 0
    v_mov_b32 v116, 0
    v_mov_b32 v117, 0
    v_mov_b32 v118, 0
    v_mov_b32 v119, 0
    v_mov_b32 v120, 0
    v_mov_b32 v121, 0
    v_mov_b32 v122, 0
    v_mov_b32 v123, 0
    v_mov_b32 v124, 0
    v_mov_b32 v125, 0
    v_mov_b32 v126, 0
    v_mov_b32 v127, 0
    s_mul_i32 s18, s44, 3
    s_add_u32 s18, s18, s47
    s_mul_i32 s18, s18, 2621440
    s_add_u32 s6, s6, s18
    s_addc_u32 s7, s7, 0
    s_mov_b32 s24, s6
    s_and_b32 s25, s7, 0xffff
    s_mov_b32 s26, 0x280000
    s_mov_b32 s27, 0x20000
    s_mul_i32 s18, s71, 36
    s_mul_i32 s19, s49, 9
    s_add_u32 s18, s18, s19
    v_add_u32 v195, s18, v194
    s_lshr_b32 s19, s70, 1
    s_and_b32 s19, s19, 1
    s_lshl_b32 s19, s19, 10
    v_add_u32 v197, s19, v195
    v_mul_u32_u24 v222, 1280, v197
    v_lshrrev_b32 v196, 4, v195
    v_mul_u32_u24 v196, 3840, v196
    v_and_b32 v200, 15, v195
    v_lshl_add_u32 v196, v200, 7, v196
    s_and_b32 s19, s70, 1
    s_mul_i32 s19, s19, 1792
    v_add_u32 v223, s19, v196
    v_mov_b32 v200, 0x40000000
    v_cmp_gt_u32 vcc, 1024, v195
    s_nop 1
    v_cndmask_b32 v222, v200, v222, vcc
    v_cndmask_b32 v223, v200, v223, vcc
    s_cmp_eq_u32 s44, 0
    s_cselect_b32 s4, s36, s40
    s_cselect_b32 s5, s37, s41
    s_mov_b32 s28, s4
    s_and_b32 s29, s5, 0xffff
    s_mov_b32 s30, 0x280000
    s_mov_b32 s31, 0x20000
    s_cmp_eq_u32 s44, 0
    s_cselect_b32 s4, s38, s42
    s_cselect_b32 s5, s39, s43
    s_mov_b32 s64, s4
    s_and_b32 s65, s5, 0xffff
    s_mov_b32 s66, 0x258000
    s_mov_b32 s67, 0x20000
    s_movk_i32 s63, 384
    s_mov_b32 s68, 737280
    s_mov_b32 exec_lo, 0x1ff
    s_mov_b32 exec_hi, 0
    buffer_load_dword v199, v222, s[28:31], s63 offen
    buffer_load_dword v199, v223, s[64:67], s68 offen
    s_mov_b64 exec, -1
    s_add_u32 s63, s63, 128
    s_add_u32 s68, s68, 245760
    s_mov_b32 exec_lo, 0x1ff
    s_mov_b32 exec_hi, 0
    buffer_load_dword v199, v222, s[28:31], s63 offen
    buffer_load_dword v199, v223, s[64:67], s68 offen
    s_mov_b64 exec, -1
    s_add_u32 s63, s63, 128
    s_add_u32 s68, s68, 245760
    s_lshl_b32 s18, s45, 3
    s_lshl_b32 s19, s50, 2
    s_add_u32 s21, s18, s19
    s_mov_b32 s59, s47
    s_cmp_eq_u32 s44, 0
    s_cbranch_scc1 concat_heads__linear_attn_block__sliding_block__prompt_kernel_varok
    s_cmp_eq_u32 s47, 2
    s_cselect_b32 s59, 2, 3
concat_heads__linear_attn_block__sliding_block__prompt_kernel_varok:
    s_cmp_eq_u32 s59, 0
    s_cbranch_scc1 concat_heads__linear_attn_block__sliding_block__prompt_kernel_adrT
    s_cmp_eq_u32 s59, 3
    s_cbranch_scc1 concat_heads__linear_attn_block__sliding_block__prompt_kernel_adrT
    s_mul_i32 s18, s21, 40960
    s_lshl_b32 s19, s48, 11
    s_add_u32 s18, s18, s19
    s_lshl_b32 s19, s51, 10
    s_add_u32 s18, s18, s19
    v_lshrrev_b32 v195, 5, v194
    v_mul_u32_u24 v195, 10240, v195
    v_and_b32 v196, 31, v194
    v_lshl_add_u32 v198, v196, 4, v195
    v_add_u32 v198, s18, v198
    s_movk_i32 s56, 512
    s_movk_i32 s57, 20480
    s_branch concat_heads__linear_attn_block__sliding_block__prompt_kernel_adrok
concat_heads__linear_attn_block__sliding_block__prompt_kernel_adrT:
    s_mul_i32 s18, s21, 40
    s_lshl_b32 s19, s48, 3
    s_add_u32 s18, s18, s19
    s_lshl_b32 s19, s51, 2
    s_add_u32 s18, s18, s19
    s_lshl_b32 s18, s18, 10
    v_lshlrev_b32 v198, 4, v194
    v_add_u32 v198, s18, v198
    s_movk_i32 s56, 2048
    s_movk_i32 s57, 1024
concat_heads__linear_attn_block__sliding_block__prompt_kernel_adrok:
    s_cmp_lt_u32 s59, 2
    s_cselect_b32 s60, 0x3fb8aa3b, 1.0
    s_cmp_eq_u32 s59, 3
    s_cbranch_scc0 concat_heads__linear_attn_block__sliding_block__prompt_kernel_c0ok
    s_cmp_eq_u32 s47, 0
    s_cselect_b32 s60, 0x3ea52b5c, 1.0
concat_heads__linear_attn_block__sliding_block__prompt_kernel_c0ok:
    s_mov_b32 s61, s60
    s_mov_b32 s62, 0x358637bd
    s_mov_b32 s52, 0
    s_mov_b32 s54, 0
    s_mov_b32 s55, 0xfffe8000
    s_barrier
    ds_read_b64_tr_b16 v[160:161], v180 offset:0
    ds_read_b64_tr_b16 v[162:163], v180 offset:1024
    ds_read_b128 v[128:131], v176 offset:0
    ds_read_b128 v[132:135], v176 offset:4096
    ds_read_b64_tr_b16 v[164:165], v181 offset:0
    ds_read_b64_tr_b16 v[166:167], v181 offset:1024
    ds_read_b128 v[136:139], v176 offset:8192
    ds_read_b128 v[140:143], v176 offset:12288
    s_cmp_eq_u32 s59, 0
    s_cbranch_scc1 concat_heads__linear_attn_block__sliding_block__prompt_kernel_loopT
    s_cmp_eq_u32 s59, 3
    s_cbranch_scc0 concat_heads__linear_attn_block__sliding_block__prompt_kernel_loopF
.p2align 4
concat_heads__linear_attn_block__sliding_block__prompt_kernel_loopT:
    s_waitcnt lgkmcnt(0)
    v_mfma_f32_32x32x16_bf16 v[0:15], v[160:163], v[128:131], v[0:15]
    ds_read_b64_tr_b16 v[168:169], v180 offset:4096
    ds_read_b64_tr_b16 v[170:171], v180 offset:5120
    v_mfma_f32_32x32x16_bf16 v[32:47], v[160:163], v[132:135], v[32:47]
    ds_read_b128 v[144:147], v177 offset:0
    ds_read_b128 v[148:151], v177 offset:4096
    v_mfma_f32_32x32x16_bf16 v[16:31], v[164:167], v[128:131], v[16:31]
    ds_read_b64_tr_b16 v[172:173], v181 offset:4096
    ds_read_b64_tr_b16 v[174:175], v181 offset:5120
    v_mfma_f32_32x32x16_bf16 v[48:63], v[164:167], v[132:135], v[48:63]
    ds_read_b128 v[152:155], v177 offset:8192
    ds_read_b128 v[156:159], v177 offset:12288
    v_mfma_f32_32x32x16_bf16 v[64:79], v[160:163], v[136:139], v[64:79]
    v_mfma_f32_32x32x16_bf16 v[80:95], v[164:167], v[136:139], v[80:95]
    s_cmp_lt_u32 s52, 5
    s_cbranch_scc0 concat_heads__linear_attn_block__sliding_block__prompt_kernel_rt1
    s_mov_b32 exec_lo, 0x1ff
    s_mov_b32 exec_hi, 0
    buffer_load_dword v199, v222, s[28:31], s63 offen
    buffer_load_dword v199, v223, s[64:67], s68 offen
    s_mov_b64 exec, -1
    s_add_u32 s63, s63, 128
    s_add_u32 s68, s68, 245760
concat_heads__linear_attn_block__sliding_block__prompt_kernel_rt1:
    v_mfma_f32_32x32x16_bf16 v[96:111], v[160:163], v[140:143], v[96:111]
    v_mfma_f32_32x32x16_bf16 v[112:127], v[164:167], v[140:143], v[112:127]
    s_waitcnt lgkmcnt(0)
    v_mfma_f32_32x32x16_bf16 v[0:15], v[168:171], v[144:147], v[0:15]
    ds_read_b64_tr_b16 v[160:161], v180 offset:8192
    ds_read_b64_tr_b16 v[162:163], v180 offset:9216
    v_mfma_f32_32x32x16_bf16 v[32:47], v[168:171], v[148:151], v[32:47]
    ds_read_b128 v[128:131], v178 offset:0
    ds_read_b128 v[132:135], v178 offset:4096
    v_mfma_f32_32x32x16_bf16 v[16:31], v[172:175], v[144:147], v[16:31]
    ds_read_b64_tr_b16 v[164:165], v181 offset:8192
    ds_read_b64_tr_b16 v[166:167], v181 offset:9216
    v_mfma_f32_32x32x16_bf16 v[48:63], v[172:175], v[148:151], v[48:63]
    ds_read_b128 v[136:139], v178 offset:8192
    ds_read_b128 v[140:143], v178 offset:12288
    v_mfma_f32_32x32x16_bf16 v[64:79], v[168:171], v[152:155], v[64:79]
    v_mfma_f32_32x32x16_bf16 v[80:95], v[172:175], v[152:155], v[80:95]
    v_mfma_f32_32x32x16_bf16 v[96:111], v[168:171], v[156:159], v[96:111]
    v_mfma_f32_32x32x16_bf16 v[112:127], v[172:175], v[156:159], v[112:127]
    s_waitcnt lgkmcnt(0)
    v_mfma_f32_32x32x16_bf16 v[0:15], v[160:163], v[128:131], v[0:15]
    ds_read_b64_tr_b16 v[168:169], v180 offset:12288
    ds_read_b64_tr_b16 v[170:171], v180 offset:13312
    v_mfma_f32_32x32x16_bf16 v[32:47], v[160:163], v[132:135], v[32:47]
    ds_read_b128 v[144:147], v179 offset:0
    ds_read_b128 v[148:151], v179 offset:4096
    v_mfma_f32_32x32x16_bf16 v[16:31], v[164:167], v[128:131], v[16:31]
    ds_read_b64_tr_b16 v[172:173], v181 offset:12288
    ds_read_b64_tr_b16 v[174:175], v181 offset:13312
    v_mfma_f32_32x32x16_bf16 v[48:63], v[164:167], v[132:135], v[48:63]
    ds_read_b128 v[152:155], v179 offset:8192
    ds_read_b128 v[156:159], v179 offset:12288
    v_mfma_f32_32x32x16_bf16 v[64:79], v[160:163], v[136:139], v[64:79]
    s_add_u32 s54, s54, 1
    s_cmp_eq_u32 s54, 3
    s_cselect_b32 s54, 0, s54
    s_cselect_b32 s53, s55, 49152
    v_mfma_f32_32x32x16_bf16 v[80:95], v[164:167], v[136:139], v[80:95]
    v_add_u32 v176, s53, v176
    v_add_u32 v177, s53, v177
    v_add_u32 v178, s53, v178
    v_mfma_f32_32x32x16_bf16 v[96:111], v[160:163], v[140:143], v[96:111]
    v_add_u32 v179, s53, v179
    v_add_u32 v180, s53, v180
    v_add_u32 v181, s53, v181
    s_add_u32 s52, s52, 1
    s_cmp_eq_u32 s52, 9
    v_mfma_f32_32x32x16_bf16 v[112:127], v[164:167], v[140:143], v[112:127]
    s_cbranch_scc1 concat_heads__linear_attn_block__sliding_block__prompt_kernel_finalT
    s_waitcnt lgkmcnt(0)
    v_mfma_f32_32x32x16_bf16 v[0:15], v[168:171], v[144:147], v[0:15]
    v_mfma_f32_32x32x16_bf16 v[32:47], v[168:171], v[148:151], v[32:47]
    s_barrier
    v_mfma_f32_32x32x16_bf16 v[16:31], v[172:175], v[144:147], v[16:31]
    ds_read_b64_tr_b16 v[160:161], v180 offset:0
    ds_read_b64_tr_b16 v[162:163], v180 offset:1024
    ds_read_b128 v[128:131], v176 offset:0
    v_mfma_f32_32x32x16_bf16 v[48:63], v[172:175], v[148:151], v[48:63]
    ds_read_b128 v[132:135], v176 offset:4096
    ds_read_b64_tr_b16 v[164:165], v181 offset:0
    ds_read_b64_tr_b16 v[166:167], v181 offset:1024
    v_mfma_f32_32x32x16_bf16 v[64:79], v[168:171], v[152:155], v[64:79]
    ds_read_b128 v[136:139], v176 offset:8192
    ds_read_b128 v[140:143], v176 offset:12288
    v_mfma_f32_32x32x16_bf16 v[80:95], v[172:175], v[152:155], v[80:95]
    v_mfma_f32_32x32x16_bf16 v[96:111], v[168:171], v[156:159], v[96:111]
    v_mfma_f32_32x32x16_bf16 v[112:127], v[172:175], v[156:159], v[112:127]
    s_branch concat_heads__linear_attn_block__sliding_block__prompt_kernel_loopT
.p2align 4
concat_heads__linear_attn_block__sliding_block__prompt_kernel_loopF:
    s_waitcnt lgkmcnt(0)
    v_mfma_f32_32x32x16_bf16 v[0:15], v[128:131], v[160:163], v[0:15]
    ds_read_b64_tr_b16 v[168:169], v180 offset:4096
    ds_read_b64_tr_b16 v[170:171], v180 offset:5120
    v_mfma_f32_32x32x16_bf16 v[32:47], v[132:135], v[160:163], v[32:47]
    ds_read_b128 v[144:147], v177 offset:0
    ds_read_b128 v[148:151], v177 offset:4096
    v_mfma_f32_32x32x16_bf16 v[16:31], v[128:131], v[164:167], v[16:31]
    ds_read_b64_tr_b16 v[172:173], v181 offset:4096
    ds_read_b64_tr_b16 v[174:175], v181 offset:5120
    v_mfma_f32_32x32x16_bf16 v[48:63], v[132:135], v[164:167], v[48:63]
    ds_read_b128 v[152:155], v177 offset:8192
    ds_read_b128 v[156:159], v177 offset:12288
    v_mfma_f32_32x32x16_bf16 v[64:79], v[136:139], v[160:163], v[64:79]
    v_mfma_f32_32x32x16_bf16 v[80:95], v[136:139], v[164:167], v[80:95]
    s_cmp_lt_u32 s52, 5
    s_cbranch_scc0 concat_heads__linear_attn_block__sliding_block__prompt_kernel_rt2
    s_mov_b32 exec_lo, 0x1ff
    s_mov_b32 exec_hi, 0
    buffer_load_dword v199, v222, s[28:31], s63 offen
    buffer_load_dword v199, v223, s[64:67], s68 offen
    s_mov_b64 exec, -1
    s_add_u32 s63, s63, 128
    s_add_u32 s68, s68, 245760
concat_heads__linear_attn_block__sliding_block__prompt_kernel_rt2:
    v_mfma_f32_32x32x16_bf16 v[96:111], v[140:143], v[160:163], v[96:111]
    v_mfma_f32_32x32x16_bf16 v[112:127], v[140:143], v[164:167], v[112:127]
    s_waitcnt lgkmcnt(0)
    v_mfma_f32_32x32x16_bf16 v[0:15], v[144:147], v[168:171], v[0:15]
    ds_read_b64_tr_b16 v[160:161], v180 offset:8192
    ds_read_b64_tr_b16 v[162:163], v180 offset:9216
    v_mfma_f32_32x32x16_bf16 v[32:47], v[148:151], v[168:171], v[32:47]
    ds_read_b128 v[128:131], v178 offset:0
    ds_read_b128 v[132:135], v178 offset:4096
    v_mfma_f32_32x32x16_bf16 v[16:31], v[144:147], v[172:175], v[16:31]
    ds_read_b64_tr_b16 v[164:165], v181 offset:8192
    ds_read_b64_tr_b16 v[166:167], v181 offset:9216
    v_mfma_f32_32x32x16_bf16 v[48:63], v[148:151], v[172:175], v[48:63]
    ds_read_b128 v[136:139], v178 offset:8192
    ds_read_b128 v[140:143], v178 offset:12288
    v_mfma_f32_32x32x16_bf16 v[64:79], v[152:155], v[168:171], v[64:79]
    v_mfma_f32_32x32x16_bf16 v[80:95], v[152:155], v[172:175], v[80:95]
    v_mfma_f32_32x32x16_bf16 v[96:111], v[156:159], v[168:171], v[96:111]
    v_mfma_f32_32x32x16_bf16 v[112:127], v[156:159], v[172:175], v[112:127]
    s_waitcnt lgkmcnt(0)
    v_mfma_f32_32x32x16_bf16 v[0:15], v[128:131], v[160:163], v[0:15]
    ds_read_b64_tr_b16 v[168:169], v180 offset:12288
    ds_read_b64_tr_b16 v[170:171], v180 offset:13312
    v_mfma_f32_32x32x16_bf16 v[32:47], v[132:135], v[160:163], v[32:47]
    ds_read_b128 v[144:147], v179 offset:0
    ds_read_b128 v[148:151], v179 offset:4096
    v_mfma_f32_32x32x16_bf16 v[16:31], v[128:131], v[164:167], v[16:31]
    ds_read_b64_tr_b16 v[172:173], v181 offset:12288
    ds_read_b64_tr_b16 v[174:175], v181 offset:13312
    v_mfma_f32_32x32x16_bf16 v[48:63], v[132:135], v[164:167], v[48:63]
    ds_read_b128 v[152:155], v179 offset:8192
    ds_read_b128 v[156:159], v179 offset:12288
    v_mfma_f32_32x32x16_bf16 v[64:79], v[136:139], v[160:163], v[64:79]
    s_add_u32 s54, s54, 1
    s_cmp_eq_u32 s54, 3
    s_cselect_b32 s54, 0, s54
    s_cselect_b32 s53, s55, 49152
    v_mfma_f32_32x32x16_bf16 v[80:95], v[136:139], v[164:167], v[80:95]
    v_add_u32 v176, s53, v176
    v_add_u32 v177, s53, v177
    v_add_u32 v178, s53, v178
    v_mfma_f32_32x32x16_bf16 v[96:111], v[140:143], v[160:163], v[96:111]
    v_add_u32 v179, s53, v179
    v_add_u32 v180, s53, v180
    v_add_u32 v181, s53, v181
    s_add_u32 s52, s52, 1
    s_cmp_eq_u32 s52, 9
    v_mfma_f32_32x32x16_bf16 v[112:127], v[140:143], v[164:167], v[112:127]
    s_cbranch_scc1 concat_heads__linear_attn_block__sliding_block__prompt_kernel_finalF
    s_waitcnt lgkmcnt(0)
    v_mfma_f32_32x32x16_bf16 v[0:15], v[144:147], v[168:171], v[0:15]
    v_mfma_f32_32x32x16_bf16 v[32:47], v[148:151], v[168:171], v[32:47]
    s_barrier
    v_mfma_f32_32x32x16_bf16 v[16:31], v[144:147], v[172:175], v[16:31]
    ds_read_b64_tr_b16 v[160:161], v180 offset:0
    ds_read_b64_tr_b16 v[162:163], v180 offset:1024
    ds_read_b128 v[128:131], v176 offset:0
    v_mfma_f32_32x32x16_bf16 v[48:63], v[148:151], v[172:175], v[48:63]
    ds_read_b128 v[132:135], v176 offset:4096
    ds_read_b64_tr_b16 v[164:165], v181 offset:0
    ds_read_b64_tr_b16 v[166:167], v181 offset:1024
    v_mfma_f32_32x32x16_bf16 v[64:79], v[152:155], v[168:171], v[64:79]
    ds_read_b128 v[136:139], v176 offset:8192
    ds_read_b128 v[140:143], v176 offset:12288
    v_mfma_f32_32x32x16_bf16 v[80:95], v[152:155], v[172:175], v[80:95]
    v_mfma_f32_32x32x16_bf16 v[96:111], v[156:159], v[168:171], v[96:111]
    v_mfma_f32_32x32x16_bf16 v[112:127], v[156:159], v[172:175], v[112:127]
    s_branch concat_heads__linear_attn_block__sliding_block__prompt_kernel_loopF
concat_heads__linear_attn_block__sliding_block__prompt_kernel_finalT:
    s_cmp_eq_u32 s59, 0
    s_cbranch_scc0 concat_heads__linear_attn_block__sliding_block__prompt_kernel_fin_ts
concat_heads__linear_attn_block__sliding_block__prompt_kernel_fin_tp:
    v_mov_b32 v222, 0
    buffer_load_dwordx2 v[220:221], v222, s[12:15], 0 offen sc1
    s_waitcnt lgkmcnt(0)
    v_mfma_f32_32x32x16_bf16 v[0:15], v[168:171], v[144:147], v[0:15]
    v_mfma_f32_32x32x16_bf16 v[32:47], v[168:171], v[148:151], v[32:47]
    s_barrier
    v_mfma_f32_32x32x16_bf16 v[16:31], v[172:175], v[144:147], v[16:31]
    ds_read_b128 v[128:131], v176
    ds_read_b64_tr_b16 v[224:225], v180 offset:0
    ds_read_b64_tr_b16 v[226:227], v180 offset:1024
    ds_read_b128 v[132:135], v177
    v_mfma_f32_32x32x16_bf16 v[48:63], v[172:175], v[148:151], v[48:63]
    ds_read_b64_tr_b16 v[228:229], v180 offset:4096
    ds_read_b64_tr_b16 v[230:231], v180 offset:5120
    ds_read_b128 v[136:139], v178
    ds_read_b64_tr_b16 v[232:233], v180 offset:8192
    v_mfma_f32_32x32x16_bf16 v[64:79], v[168:171], v[152:155], v[64:79]
    ds_read_b64_tr_b16 v[234:235], v180 offset:9216
    ds_read_b128 v[140:143], v179
    ds_read_b64_tr_b16 v[236:237], v180 offset:12288
    v_mfma_f32_32x32x16_bf16 v[80:95], v[172:175], v[152:155], v[80:95]
    ds_read_b64_tr_b16 v[238:239], v180 offset:13312
    ds_read_b64_tr_b16 v[240:241], v181 offset:0
    ds_read_b64_tr_b16 v[242:243], v181 offset:1024
    v_mfma_f32_32x32x16_bf16 v[96:111], v[168:171], v[156:159], v[96:111]
    ds_read_b64_tr_b16 v[244:245], v181 offset:4096
    ds_read_b64_tr_b16 v[246:247], v181 offset:5120
    ds_read_b64_tr_b16 v[248:249], v181 offset:8192
    v_mfma_f32_32x32x16_bf16 v[112:127], v[172:175], v[156:159], v[112:127]
    ds_read_b64_tr_b16 v[250:251], v181 offset:9216
    ds_read_b64_tr_b16 v[252:253], v181 offset:12288
    ds_read_b64_tr_b16 v[254:255], v181 offset:13312
    s_waitcnt lgkmcnt(8)
    v_mfma_f32_32x32x16_bf16 v[0:15], v[224:227], v[128:131], v[0:15]
    ds_read_b128 v[144:147], v176 offset:4096
    v_mfma_f32_32x32x16_bf16 v[0:15], v[228:231], v[132:135], v[0:15]
    ds_read_b128 v[148:151], v177 offset:4096
    v_mfma_f32_32x32x16_bf16 v[0:15], v[232:235], v[136:139], v[0:15]
    ds_read_b128 v[152:155], v178 offset:4096
    v_mfma_f32_32x32x16_bf16 v[0:15], v[236:239], v[140:143], v[0:15]
    ds_read_b128 v[156:159], v179 offset:4096
    s_waitcnt lgkmcnt(4)
    v_mfma_f32_32x32x16_bf16 v[16:31], v[240:243], v[128:131], v[16:31]
    v_mfma_f32_32x32x16_bf16 v[16:31], v[244:247], v[132:135], v[16:31]
    v_mfma_f32_32x32x16_bf16 v[16:31], v[248:251], v[136:139], v[16:31]
    v_mfma_f32_32x32x16_bf16 v[16:31], v[252:255], v[140:143], v[16:31]
    s_waitcnt lgkmcnt(0)
    v_mfma_f32_32x32x16_bf16 v[32:47], v[224:227], v[144:147], v[32:47]
    ds_read_b128 v[128:131], v176 offset:8192
    s_nop 7
    v_pk_mul_f32 v[216:217], v[0:1], s[60:61]
    v_pk_mul_f32 v[218:219], v[2:3], s[60:61]
    v_exp_f32_e64 v216, v216 clamp
    v_exp_f32_e64 v217, v217 clamp
    v_exp_f32_e64 v218, v218 clamp
    v_exp_f32_e64 v219, v219 clamp
    v_max_f32 v0, s62, v0
    v_max_f32 v1, s62, v1
    v_max_f32 v2, s62, v2
    v_max_f32 v3, s62, v3
    v_pk_add_f32 v[0:1], v[0:1], v[216:217]
    v_pk_add_f32 v[2:3], v[2:3], v[218:219]
    v_cvt_pk_bf16_f32 v200, v0, v1
    v_cvt_pk_bf16_f32 v201, v2, v3
    v_pk_mul_f32 v[216:217], v[4:5], s[60:61]
    v_mfma_f32_32x32x16_bf16 v[32:47], v[228:231], v[148:151], v[32:47]
    ds_read_b128 v[132:135], v177 offset:8192
    v_pk_mul_f32 v[218:219], v[6:7], s[60:61]
    v_exp_f32_e64 v216, v216 clamp
    v_exp_f32_e64 v217, v217 clamp
    v_exp_f32_e64 v218, v218 clamp
    v_exp_f32_e64 v219, v219 clamp
    v_max_f32 v4, s62, v4
    v_max_f32 v5, s62, v5
    v_max_f32 v6, s62, v6
    v_max_f32 v7, s62, v7
    v_pk_add_f32 v[4:5], v[4:5], v[216:217]
    v_pk_add_f32 v[6:7], v[6:7], v[218:219]
    v_cvt_pk_bf16_f32 v202, v4, v5
    v_cvt_pk_bf16_f32 v203, v6, v7
    v_pk_mul_f32 v[216:217], v[8:9], s[60:61]
    v_pk_mul_f32 v[218:219], v[10:11], s[60:61]
    v_exp_f32_e64 v216, v216 clamp
    v_mfma_f32_32x32x16_bf16 v[32:47], v[232:235], v[152:155], v[32:47]
    ds_read_b128 v[136:139], v178 offset:8192
    v_exp_f32_e64 v217, v217 clamp
    v_exp_f32_e64 v218, v218 clamp
    v_exp_f32_e64 v219, v219 clamp
    v_max_f32 v8, s62, v8
    v_max_f32 v9, s62, v9
    v_max_f32 v10, s62, v10
    v_max_f32 v11, s62, v11
    v_pk_add_f32 v[8:9], v[8:9], v[216:217]
    v_pk_add_f32 v[10:11], v[10:11], v[218:219]
    v_cvt_pk_bf16_f32 v204, v8, v9
    v_cvt_pk_bf16_f32 v205, v10, v11
    v_pk_mul_f32 v[216:217], v[12:13], s[60:61]
    v_pk_mul_f32 v[218:219], v[14:15], s[60:61]
    v_exp_f32_e64 v216, v216 clamp
    v_exp_f32_e64 v217, v217 clamp
    v_exp_f32_e64 v218, v218 clamp
    v_mfma_f32_32x32x16_bf16 v[32:47], v[236:239], v[156:159], v[32:47]
    ds_read_b128 v[140:143], v179 offset:8192
    v_exp_f32_e64 v219, v219 clamp
    v_max_f32 v12, s62, v12
    v_max_f32 v13, s62, v13
    v_max_f32 v14, s62, v14
    v_max_f32 v15, s62, v15
    v_pk_add_f32 v[12:13], v[12:13], v[216:217]
    v_pk_add_f32 v[14:15], v[14:15], v[218:219]
    v_cvt_pk_bf16_f32 v206, v12, v13
    v_cvt_pk_bf16_f32 v207, v14, v15
    s_mul_i32 s58, s56, 0
    buffer_store_dwordx4 v[200:203], v198, s[24:27], s58 offen sc1
    s_add_u32 s58, s58, s57
    buffer_store_dwordx4 v[204:207], v198, s[24:27], s58 offen sc1
    v_mfma_f32_32x32x16_bf16 v[48:63], v[240:243], v[144:147], v[48:63]
    v_pk_mul_f32 v[216:217], v[16:17], s[60:61]
    v_pk_mul_f32 v[218:219], v[18:19], s[60:61]
    v_exp_f32_e64 v216, v216 clamp
    v_exp_f32_e64 v217, v217 clamp
    v_exp_f32_e64 v218, v218 clamp
    v_exp_f32_e64 v219, v219 clamp
    v_max_f32 v16, s62, v16
    v_max_f32 v17, s62, v17
    v_max_f32 v18, s62, v18
    v_max_f32 v19, s62, v19
    v_pk_add_f32 v[16:17], v[16:17], v[216:217]
    v_pk_add_f32 v[18:19], v[18:19], v[218:219]
    v_cvt_pk_bf16_f32 v208, v16, v17
    v_cvt_pk_bf16_f32 v209, v18, v19
    v_pk_mul_f32 v[216:217], v[20:21], s[60:61]
    v_mfma_f32_32x32x16_bf16 v[48:63], v[244:247], v[148:151], v[48:63]
    v_pk_mul_f32 v[218:219], v[22:23], s[60:61]
    v_exp_f32_e64 v216, v216 clamp
    v_exp_f32_e64 v217, v217 clamp
    v_exp_f32_e64 v218, v218 clamp
    v_exp_f32_e64 v219, v219 clamp
    v_max_f32 v20, s62, v20
    v_max_f32 v21, s62, v21
    v_max_f32 v22, s62, v22
    v_max_f32 v23, s62, v23
    v_pk_add_f32 v[20:21], v[20:21], v[216:217]
    v_pk_add_f32 v[22:23], v[22:23], v[218:219]
    v_cvt_pk_bf16_f32 v210, v20, v21
    v_cvt_pk_bf16_f32 v211, v22, v23
    v_pk_mul_f32 v[216:217], v[24:25], s[60:61]
    v_pk_mul_f32 v[218:219], v[26:27], s[60:61]
    v_mfma_f32_32x32x16_bf16 v[48:63], v[248:251], v[152:155], v[48:63]
    v_exp_f32_e64 v216, v216 clamp
    v_exp_f32_e64 v217, v217 clamp
    v_exp_f32_e64 v218, v218 clamp
    v_exp_f32_e64 v219, v219 clamp
    v_max_f32 v24, s62, v24
    v_max_f32 v25, s62, v25
    v_max_f32 v26, s62, v26
    v_max_f32 v27, s62, v27
    v_pk_add_f32 v[24:25], v[24:25], v[216:217]
    v_pk_add_f32 v[26:27], v[26:27], v[218:219]
    v_cvt_pk_bf16_f32 v212, v24, v25
    v_cvt_pk_bf16_f32 v213, v26, v27
    v_pk_mul_f32 v[216:217], v[28:29], s[60:61]
    v_pk_mul_f32 v[218:219], v[30:31], s[60:61]
    v_exp_f32_e64 v216, v216 clamp
    v_mfma_f32_32x32x16_bf16 v[48:63], v[252:255], v[156:159], v[48:63]
    v_exp_f32_e64 v217, v217 clamp
    v_exp_f32_e64 v218, v218 clamp
    v_exp_f32_e64 v219, v219 clamp
    v_max_f32 v28, s62, v28
    v_max_f32 v29, s62, v29
    v_max_f32 v30, s62, v30
    v_max_f32 v31, s62, v31
    v_pk_add_f32 v[28:29], v[28:29], v[216:217]
    v_pk_add_f32 v[30:31], v[30:31], v[218:219]
    v_cvt_pk_bf16_f32 v214, v28, v29
    v_cvt_pk_bf16_f32 v215, v30, v31
    s_mul_i32 s58, s56, 1
    buffer_store_dwordx4 v[208:211], v198, s[24:27], s58 offen sc1
    s_add_u32 s58, s58, s57
    buffer_store_dwordx4 v[212:215], v198, s[24:27], s58 offen sc1
    s_waitcnt lgkmcnt(0)
    v_mfma_f32_32x32x16_bf16 v[64:79], v[224:227], v[128:131], v[64:79]
    ds_read_b128 v[144:147], v176 offset:12288
    v_pk_mul_f32 v[216:217], v[32:33], s[60:61]
    v_pk_mul_f32 v[218:219], v[34:35], s[60:61]
    v_exp_f32_e64 v216, v216 clamp
    v_exp_f32_e64 v217, v217 clamp
    v_exp_f32_e64 v218, v218 clamp
    v_exp_f32_e64 v219, v219 clamp
    v_max_f32 v32, s62, v32
    v_max_f32 v33, s62, v33
    v_max_f32 v34, s62, v34
    v_max_f32 v35, s62, v35
    v_pk_add_f32 v[32:33], v[32:33], v[216:217]
    v_pk_add_f32 v[34:35], v[34:35], v[218:219]
    v_cvt_pk_bf16_f32 v200, v32, v33
    v_cvt_pk_bf16_f32 v201, v34, v35
    v_pk_mul_f32 v[216:217], v[36:37], s[60:61]
    v_pk_mul_f32 v[218:219], v[38:39], s[60:61]
    v_mfma_f32_32x32x16_bf16 v[64:79], v[228:231], v[132:135], v[64:79]
    ds_read_b128 v[148:151], v177 offset:12288
    v_exp_f32_e64 v216, v216 clamp
    v_exp_f32_e64 v217, v217 clamp
    v_exp_f32_e64 v218, v218 clamp
    v_exp_f32_e64 v219, v219 clamp
    v_max_f32 v36, s62, v36
    v_max_f32 v37, s62, v37
    v_max_f32 v38, s62, v38
    v_max_f32 v39, s62, v39
    v_pk_add_f32 v[36:37], v[36:37], v[216:217]
    v_pk_add_f32 v[38:39], v[38:39], v[218:219]
    v_cvt_pk_bf16_f32 v202, v36, v37
    v_cvt_pk_bf16_f32 v203, v38, v39
    v_pk_mul_f32 v[216:217], v[40:41], s[60:61]
    v_pk_mul_f32 v[218:219], v[42:43], s[60:61]
    v_exp_f32_e64 v216, v216 clamp
    v_exp_f32_e64 v217, v217 clamp
    v_mfma_f32_32x32x16_bf16 v[64:79], v[232:235], v[136:139], v[64:79]
    ds_read_b128 v[152:155], v178 offset:12288
    v_exp_f32_e64 v218, v218 clamp
    v_exp_f32_e64 v219, v219 clamp
    v_max_f32 v40, s62, v40
    v_max_f32 v41, s62, v41
    v_max_f32 v42, s62, v42
    v_max_f32 v43, s62, v43
    v_pk_add_f32 v[40:41], v[40:41], v[216:217]
    v_pk_add_f32 v[42:43], v[42:43], v[218:219]
    v_cvt_pk_bf16_f32 v204, v40, v41
    v_cvt_pk_bf16_f32 v205, v42, v43
    v_pk_mul_f32 v[216:217], v[44:45], s[60:61]
    v_pk_mul_f32 v[218:219], v[46:47], s[60:61]
    v_exp_f32_e64 v216, v216 clamp
    v_exp_f32_e64 v217, v217 clamp
    v_exp_f32_e64 v218, v218 clamp
    v_exp_f32_e64 v219, v219 clamp
    v_mfma_f32_32x32x16_bf16 v[64:79], v[236:239], v[140:143], v[64:79]
    ds_read_b128 v[156:159], v179 offset:12288
    v_max_f32 v44, s62, v44
    v_max_f32 v45, s62, v45
    v_max_f32 v46, s62, v46
    v_max_f32 v47, s62, v47
    v_pk_add_f32 v[44:45], v[44:45], v[216:217]
    v_pk_add_f32 v[46:47], v[46:47], v[218:219]
    v_cvt_pk_bf16_f32 v206, v44, v45
    v_cvt_pk_bf16_f32 v207, v46, v47
    s_mul_i32 s58, s56, 0
    s_add_u32 s58, s58, 40960
    buffer_store_dwordx4 v[200:203], v198, s[24:27], s58 offen sc1
    s_add_u32 s58, s58, s57
    buffer_store_dwordx4 v[204:207], v198, s[24:27], s58 offen sc1
    v_mfma_f32_32x32x16_bf16 v[80:95], v[240:243], v[128:131], v[80:95]
    v_pk_mul_f32 v[216:217], v[48:49], s[60:61]
    v_pk_mul_f32 v[218:219], v[50:51], s[60:61]
    v_exp_f32_e64 v216, v216 clamp
    v_exp_f32_e64 v217, v217 clamp
    v_exp_f32_e64 v218, v218 clamp
    v_exp_f32_e64 v219, v219 clamp
    v_max_f32 v48, s62, v48
    v_max_f32 v49, s62, v49
    v_max_f32 v50, s62, v50
    v_max_f32 v51, s62, v51
    v_pk_add_f32 v[48:49], v[48:49], v[216:217]
    v_pk_add_f32 v[50:51], v[50:51], v[218:219]
    v_cvt_pk_bf16_f32 v208, v48, v49
    v_cvt_pk_bf16_f32 v209, v50, v51
    v_pk_mul_f32 v[216:217], v[52:53], s[60:61]
    v_pk_mul_f32 v[218:219], v[54:55], s[60:61]
    v_mfma_f32_32x32x16_bf16 v[80:95], v[244:247], v[132:135], v[80:95]
    v_exp_f32_e64 v216, v216 clamp
    v_exp_f32_e64 v217, v217 clamp
    v_exp_f32_e64 v218, v218 clamp
    v_exp_f32_e64 v219, v219 clamp
    v_max_f32 v52, s62, v52
    v_max_f32 v53, s62, v53
    v_max_f32 v54, s62, v54
    v_max_f32 v55, s62, v55
    v_pk_add_f32 v[52:53], v[52:53], v[216:217]
    v_pk_add_f32 v[54:55], v[54:55], v[218:219]
    v_cvt_pk_bf16_f32 v210, v52, v53
    v_cvt_pk_bf16_f32 v211, v54, v55
    v_pk_mul_f32 v[216:217], v[56:57], s[60:61]
    v_pk_mul_f32 v[218:219], v[58:59], s[60:61]
    v_exp_f32_e64 v216, v216 clamp
    v_exp_f32_e64 v217, v217 clamp
    v_mfma_f32_32x32x16_bf16 v[80:95], v[248:251], v[136:139], v[80:95]
    v_exp_f32_e64 v218, v218 clamp
    v_exp_f32_e64 v219, v219 clamp
    v_max_f32 v56, s62, v56
    v_max_f32 v57, s62, v57
    v_max_f32 v58, s62, v58
    v_max_f32 v59, s62, v59
    v_pk_add_f32 v[56:57], v[56:57], v[216:217]
    v_pk_add_f32 v[58:59], v[58:59], v[218:219]
    v_cvt_pk_bf16_f32 v212, v56, v57
    v_cvt_pk_bf16_f32 v213, v58, v59
    v_pk_mul_f32 v[216:217], v[60:61], s[60:61]
    v_pk_mul_f32 v[218:219], v[62:63], s[60:61]
    v_exp_f32_e64 v216, v216 clamp
    v_exp_f32_e64 v217, v217 clamp
    v_exp_f32_e64 v218, v218 clamp
    v_exp_f32_e64 v219, v219 clamp
    v_mfma_f32_32x32x16_bf16 v[80:95], v[252:255], v[140:143], v[80:95]
    v_max_f32 v60, s62, v60
    v_max_f32 v61, s62, v61
    v_max_f32 v62, s62, v62
    v_max_f32 v63, s62, v63
    v_pk_add_f32 v[60:61], v[60:61], v[216:217]
    v_pk_add_f32 v[62:63], v[62:63], v[218:219]
    v_cvt_pk_bf16_f32 v214, v60, v61
    v_cvt_pk_bf16_f32 v215, v62, v63
    s_mul_i32 s58, s56, 1
    s_add_u32 s58, s58, 40960
    buffer_store_dwordx4 v[208:211], v198, s[24:27], s58 offen sc1
    s_add_u32 s58, s58, s57
    buffer_store_dwordx4 v[212:215], v198, s[24:27], s58 offen sc1
    s_waitcnt lgkmcnt(0)
    s_barrier
    v_mfma_f32_32x32x16_bf16 v[96:111], v[224:227], v[144:147], v[96:111]
    v_pk_mul_f32 v[216:217], v[64:65], s[60:61]
    v_pk_mul_f32 v[218:219], v[66:67], s[60:61]
    v_exp_f32_e64 v216, v216 clamp
    v_exp_f32_e64 v217, v217 clamp
    v_exp_f32_e64 v218, v218 clamp
    v_exp_f32_e64 v219, v219 clamp
    v_max_f32 v64, s62, v64
    v_max_f32 v65, s62, v65
    v_max_f32 v66, s62, v66
    v_max_f32 v67, s62, v67
    v_pk_add_f32 v[64:65], v[64:65], v[216:217]
    v_pk_add_f32 v[66:67], v[66:67], v[218:219]
    v_cvt_pk_bf16_f32 v200, v64, v65
    v_cvt_pk_bf16_f32 v201, v66, v67
    v_pk_mul_f32 v[216:217], v[68:69], s[60:61]
    v_pk_mul_f32 v[218:219], v[70:71], s[60:61]
    v_mfma_f32_32x32x16_bf16 v[96:111], v[228:231], v[148:151], v[96:111]
    v_exp_f32_e64 v216, v216 clamp
    v_exp_f32_e64 v217, v217 clamp
    v_exp_f32_e64 v218, v218 clamp
    v_exp_f32_e64 v219, v219 clamp
    v_max_f32 v68, s62, v68
    v_max_f32 v69, s62, v69
    v_max_f32 v70, s62, v70
    v_max_f32 v71, s62, v71
    v_pk_add_f32 v[68:69], v[68:69], v[216:217]
    v_pk_add_f32 v[70:71], v[70:71], v[218:219]
    v_cvt_pk_bf16_f32 v202, v68, v69
    v_cvt_pk_bf16_f32 v203, v70, v71
    v_pk_mul_f32 v[216:217], v[72:73], s[60:61]
    v_pk_mul_f32 v[218:219], v[74:75], s[60:61]
    v_exp_f32_e64 v216, v216 clamp
    v_exp_f32_e64 v217, v217 clamp
    v_mfma_f32_32x32x16_bf16 v[96:111], v[232:235], v[152:155], v[96:111]
    v_exp_f32_e64 v218, v218 clamp
    v_exp_f32_e64 v219, v219 clamp
    v_max_f32 v72, s62, v72
    v_max_f32 v73, s62, v73
    v_max_f32 v74, s62, v74
    v_max_f32 v75, s62, v75
    v_pk_add_f32 v[72:73], v[72:73], v[216:217]
    v_pk_add_f32 v[74:75], v[74:75], v[218:219]
    v_cvt_pk_bf16_f32 v204, v72, v73
    v_cvt_pk_bf16_f32 v205, v74, v75
    v_pk_mul_f32 v[216:217], v[76:77], s[60:61]
    v_pk_mul_f32 v[218:219], v[78:79], s[60:61]
    v_exp_f32_e64 v216, v216 clamp
    v_exp_f32_e64 v217, v217 clamp
    v_exp_f32_e64 v218, v218 clamp
    v_exp_f32_e64 v219, v219 clamp
    v_mfma_f32_32x32x16_bf16 v[96:111], v[236:239], v[156:159], v[96:111]
    v_max_f32 v76, s62, v76
    v_max_f32 v77, s62, v77
    v_max_f32 v78, s62, v78
    v_max_f32 v79, s62, v79
    v_pk_add_f32 v[76:77], v[76:77], v[216:217]
    v_pk_add_f32 v[78:79], v[78:79], v[218:219]
    v_cvt_pk_bf16_f32 v206, v76, v77
    v_cvt_pk_bf16_f32 v207, v78, v79
    s_mul_i32 s58, s56, 0
    s_add_u32 s58, s58, 81920
    buffer_store_dwordx4 v[200:203], v198, s[24:27], s58 offen sc1
    s_add_u32 s58, s58, s57
    buffer_store_dwordx4 v[204:207], v198, s[24:27], s58 offen sc1
    v_mfma_f32_32x32x16_bf16 v[112:127], v[240:243], v[144:147], v[112:127]
    v_pk_mul_f32 v[216:217], v[80:81], s[60:61]
    v_pk_mul_f32 v[218:219], v[82:83], s[60:61]
    v_exp_f32_e64 v216, v216 clamp
    v_exp_f32_e64 v217, v217 clamp
    v_exp_f32_e64 v218, v218 clamp
    v_exp_f32_e64 v219, v219 clamp
    v_max_f32 v80, s62, v80
    v_max_f32 v81, s62, v81
    v_max_f32 v82, s62, v82
    v_max_f32 v83, s62, v83
    v_pk_add_f32 v[80:81], v[80:81], v[216:217]
    v_pk_add_f32 v[82:83], v[82:83], v[218:219]
    v_cvt_pk_bf16_f32 v208, v80, v81
    v_cvt_pk_bf16_f32 v209, v82, v83
    v_pk_mul_f32 v[216:217], v[84:85], s[60:61]
    v_pk_mul_f32 v[218:219], v[86:87], s[60:61]
    v_mfma_f32_32x32x16_bf16 v[112:127], v[244:247], v[148:151], v[112:127]
    v_exp_f32_e64 v216, v216 clamp
    v_exp_f32_e64 v217, v217 clamp
    v_exp_f32_e64 v218, v218 clamp
    v_exp_f32_e64 v219, v219 clamp
    v_max_f32 v84, s62, v84
    v_max_f32 v85, s62, v85
    v_max_f32 v86, s62, v86
    v_max_f32 v87, s62, v87
    v_pk_add_f32 v[84:85], v[84:85], v[216:217]
    v_pk_add_f32 v[86:87], v[86:87], v[218:219]
    v_cvt_pk_bf16_f32 v210, v84, v85
    v_cvt_pk_bf16_f32 v211, v86, v87
    v_pk_mul_f32 v[216:217], v[88:89], s[60:61]
    v_pk_mul_f32 v[218:219], v[90:91], s[60:61]
    v_exp_f32_e64 v216, v216 clamp
    v_exp_f32_e64 v217, v217 clamp
    v_mfma_f32_32x32x16_bf16 v[112:127], v[248:251], v[152:155], v[112:127]
    v_exp_f32_e64 v218, v218 clamp
    v_exp_f32_e64 v219, v219 clamp
    v_max_f32 v88, s62, v88
    v_max_f32 v89, s62, v89
    v_max_f32 v90, s62, v90
    v_max_f32 v91, s62, v91
    v_pk_add_f32 v[88:89], v[88:89], v[216:217]
    v_pk_add_f32 v[90:91], v[90:91], v[218:219]
    v_cvt_pk_bf16_f32 v212, v88, v89
    v_cvt_pk_bf16_f32 v213, v90, v91
    v_pk_mul_f32 v[216:217], v[92:93], s[60:61]
    v_pk_mul_f32 v[218:219], v[94:95], s[60:61]
    v_exp_f32_e64 v216, v216 clamp
    v_exp_f32_e64 v217, v217 clamp
    v_exp_f32_e64 v218, v218 clamp
    v_exp_f32_e64 v219, v219 clamp
    v_mfma_f32_32x32x16_bf16 v[112:127], v[252:255], v[156:159], v[112:127]
    v_max_f32 v92, s62, v92
    v_max_f32 v93, s62, v93
    v_max_f32 v94, s62, v94
    v_max_f32 v95, s62, v95
    v_pk_add_f32 v[92:93], v[92:93], v[216:217]
    v_pk_add_f32 v[94:95], v[94:95], v[218:219]
    v_cvt_pk_bf16_f32 v214, v92, v93
    v_cvt_pk_bf16_f32 v215, v94, v95
    s_mul_i32 s58, s56, 1
    s_add_u32 s58, s58, 81920
    buffer_store_dwordx4 v[208:211], v198, s[24:27], s58 offen sc1
    s_add_u32 s58, s58, s57
    buffer_store_dwordx4 v[212:215], v198, s[24:27], s58 offen sc1
    v_pk_mul_f32 v[216:217], v[96:97], s[60:61]
    v_pk_mul_f32 v[218:219], v[98:99], s[60:61]
    v_exp_f32_e64 v216, v216 clamp
    v_exp_f32_e64 v217, v217 clamp
    v_exp_f32_e64 v218, v218 clamp
    v_exp_f32_e64 v219, v219 clamp
    v_max_f32 v96, s62, v96
    v_max_f32 v97, s62, v97
    v_max_f32 v98, s62, v98
    v_max_f32 v99, s62, v99
    v_pk_add_f32 v[96:97], v[96:97], v[216:217]
    v_pk_add_f32 v[98:99], v[98:99], v[218:219]
    v_cvt_pk_bf16_f32 v200, v96, v97
    v_cvt_pk_bf16_f32 v201, v98, v99
    v_pk_mul_f32 v[216:217], v[100:101], s[60:61]
    v_pk_mul_f32 v[218:219], v[102:103], s[60:61]
    v_exp_f32_e64 v216, v216 clamp
    v_exp_f32_e64 v217, v217 clamp
    v_exp_f32_e64 v218, v218 clamp
    v_exp_f32_e64 v219, v219 clamp
    v_max_f32 v100, s62, v100
    v_max_f32 v101, s62, v101
    v_max_f32 v102, s62, v102
    v_max_f32 v103, s62, v103
    v_pk_add_f32 v[100:101], v[100:101], v[216:217]
    v_pk_add_f32 v[102:103], v[102:103], v[218:219]
    v_cvt_pk_bf16_f32 v202, v100, v101
    v_cvt_pk_bf16_f32 v203, v102, v103
    v_pk_mul_f32 v[216:217], v[104:105], s[60:61]
    v_pk_mul_f32 v[218:219], v[106:107], s[60:61]
    v_exp_f32_e64 v216, v216 clamp
    v_exp_f32_e64 v217, v217 clamp
    v_exp_f32_e64 v218, v218 clamp
    v_exp_f32_e64 v219, v219 clamp
    v_max_f32 v104, s62, v104
    v_max_f32 v105, s62, v105
    v_max_f32 v106, s62, v106
    v_max_f32 v107, s62, v107
    v_pk_add_f32 v[104:105], v[104:105], v[216:217]
    v_pk_add_f32 v[106:107], v[106:107], v[218:219]
    v_cvt_pk_bf16_f32 v204, v104, v105
    v_cvt_pk_bf16_f32 v205, v106, v107
    v_pk_mul_f32 v[216:217], v[108:109], s[60:61]
    v_pk_mul_f32 v[218:219], v[110:111], s[60:61]
    v_exp_f32_e64 v216, v216 clamp
    v_exp_f32_e64 v217, v217 clamp
    v_exp_f32_e64 v218, v218 clamp
    v_exp_f32_e64 v219, v219 clamp
    v_max_f32 v108, s62, v108
    v_max_f32 v109, s62, v109
    v_max_f32 v110, s62, v110
    v_max_f32 v111, s62, v111
    v_pk_add_f32 v[108:109], v[108:109], v[216:217]
    v_pk_add_f32 v[110:111], v[110:111], v[218:219]
    v_cvt_pk_bf16_f32 v206, v108, v109
    v_cvt_pk_bf16_f32 v207, v110, v111
    s_mul_i32 s58, s56, 0
    s_add_u32 s58, s58, 122880
    buffer_store_dwordx4 v[200:203], v198, s[24:27], s58 offen sc1
    s_add_u32 s58, s58, s57
    buffer_store_dwordx4 v[204:207], v198, s[24:27], s58 offen sc1
    v_pk_mul_f32 v[216:217], v[112:113], s[60:61]
    v_pk_mul_f32 v[218:219], v[114:115], s[60:61]
    v_exp_f32_e64 v216, v216 clamp
    v_exp_f32_e64 v217, v217 clamp
    v_exp_f32_e64 v218, v218 clamp
    v_exp_f32_e64 v219, v219 clamp
    v_max_f32 v112, s62, v112
    v_max_f32 v113, s62, v113
    v_max_f32 v114, s62, v114
    v_max_f32 v115, s62, v115
    v_pk_add_f32 v[112:113], v[112:113], v[216:217]
    v_pk_add_f32 v[114:115], v[114:115], v[218:219]
    v_cvt_pk_bf16_f32 v208, v112, v113
    v_cvt_pk_bf16_f32 v209, v114, v115
    v_pk_mul_f32 v[216:217], v[116:117], s[60:61]
    v_pk_mul_f32 v[218:219], v[118:119], s[60:61]
    v_exp_f32_e64 v216, v216 clamp
    v_exp_f32_e64 v217, v217 clamp
    v_exp_f32_e64 v218, v218 clamp
    v_exp_f32_e64 v219, v219 clamp
    v_max_f32 v116, s62, v116
    v_max_f32 v117, s62, v117
    v_max_f32 v118, s62, v118
    v_max_f32 v119, s62, v119
    v_pk_add_f32 v[116:117], v[116:117], v[216:217]
    v_pk_add_f32 v[118:119], v[118:119], v[218:219]
    v_cvt_pk_bf16_f32 v210, v116, v117
    v_cvt_pk_bf16_f32 v211, v118, v119
    v_pk_mul_f32 v[216:217], v[120:121], s[60:61]
    v_pk_mul_f32 v[218:219], v[122:123], s[60:61]
    v_exp_f32_e64 v216, v216 clamp
    v_exp_f32_e64 v217, v217 clamp
    v_exp_f32_e64 v218, v218 clamp
    v_exp_f32_e64 v219, v219 clamp
    v_max_f32 v120, s62, v120
    v_max_f32 v121, s62, v121
    v_max_f32 v122, s62, v122
    v_max_f32 v123, s62, v123
    v_pk_add_f32 v[120:121], v[120:121], v[216:217]
    v_pk_add_f32 v[122:123], v[122:123], v[218:219]
    v_cvt_pk_bf16_f32 v212, v120, v121
    v_cvt_pk_bf16_f32 v213, v122, v123
    v_pk_mul_f32 v[216:217], v[124:125], s[60:61]
    v_pk_mul_f32 v[218:219], v[126:127], s[60:61]
    v_exp_f32_e64 v216, v216 clamp
    v_exp_f32_e64 v217, v217 clamp
    v_exp_f32_e64 v218, v218 clamp
    v_exp_f32_e64 v219, v219 clamp
    v_max_f32 v124, s62, v124
    v_max_f32 v125, s62, v125
    v_max_f32 v126, s62, v126
    v_max_f32 v127, s62, v127
    v_pk_add_f32 v[124:125], v[124:125], v[216:217]
    v_pk_add_f32 v[126:127], v[126:127], v[218:219]
    v_cvt_pk_bf16_f32 v214, v124, v125
    v_cvt_pk_bf16_f32 v215, v126, v127
    s_mul_i32 s58, s56, 1
    s_add_u32 s58, s58, 122880
    buffer_store_dwordx4 v[208:211], v198, s[24:27], s58 offen sc1
    s_add_u32 s58, s58, s57
    buffer_store_dwordx4 v[212:215], v198, s[24:27], s58 offen sc1
    s_branch concat_heads__linear_attn_block__sliding_block__prompt_kernel_fin1
concat_heads__linear_attn_block__sliding_block__prompt_kernel_fin_ts:
    v_mov_b32 v222, 0
    buffer_load_dwordx2 v[220:221], v222, s[12:15], 0 offen sc1
    s_waitcnt lgkmcnt(0)
    v_mfma_f32_32x32x16_bf16 v[0:15], v[168:171], v[144:147], v[0:15]
    v_mfma_f32_32x32x16_bf16 v[32:47], v[168:171], v[148:151], v[32:47]
    s_barrier
    v_mfma_f32_32x32x16_bf16 v[16:31], v[172:175], v[144:147], v[16:31]
    ds_read_b128 v[128:131], v176
    ds_read_b64_tr_b16 v[224:225], v180 offset:0
    ds_read_b64_tr_b16 v[226:227], v180 offset:1024
    ds_read_b128 v[132:135], v177
    v_mfma_f32_32x32x16_bf16 v[48:63], v[172:175], v[148:151], v[48:63]
    ds_read_b64_tr_b16 v[228:229], v180 offset:4096
    ds_read_b64_tr_b16 v[230:231], v180 offset:5120
    ds_read_b128 v[136:139], v178
    ds_read_b64_tr_b16 v[232:233], v180 offset:8192
    v_mfma_f32_32x32x16_bf16 v[64:79], v[168:171], v[152:155], v[64:79]
    ds_read_b64_tr_b16 v[234:235], v180 offset:9216
    ds_read_b128 v[140:143], v179
    ds_read_b64_tr_b16 v[236:237], v180 offset:12288
    v_mfma_f32_32x32x16_bf16 v[80:95], v[172:175], v[152:155], v[80:95]
    ds_read_b64_tr_b16 v[238:239], v180 offset:13312
    ds_read_b64_tr_b16 v[240:241], v181 offset:0
    ds_read_b64_tr_b16 v[242:243], v181 offset:1024
    v_mfma_f32_32x32x16_bf16 v[96:111], v[168:171], v[156:159], v[96:111]
    ds_read_b64_tr_b16 v[244:245], v181 offset:4096
    ds_read_b64_tr_b16 v[246:247], v181 offset:5120
    ds_read_b64_tr_b16 v[248:249], v181 offset:8192
    v_mfma_f32_32x32x16_bf16 v[112:127], v[172:175], v[156:159], v[112:127]
    ds_read_b64_tr_b16 v[250:251], v181 offset:9216
    ds_read_b64_tr_b16 v[252:253], v181 offset:12288
    ds_read_b64_tr_b16 v[254:255], v181 offset:13312
    s_waitcnt lgkmcnt(8)
    v_mfma_f32_32x32x16_bf16 v[0:15], v[224:227], v[128:131], v[0:15]
    ds_read_b128 v[144:147], v176 offset:4096
    v_mfma_f32_32x32x16_bf16 v[0:15], v[228:231], v[132:135], v[0:15]
    ds_read_b128 v[148:151], v177 offset:4096
    v_mfma_f32_32x32x16_bf16 v[0:15], v[232:235], v[136:139], v[0:15]
    ds_read_b128 v[152:155], v178 offset:4096
    v_mfma_f32_32x32x16_bf16 v[0:15], v[236:239], v[140:143], v[0:15]
    ds_read_b128 v[156:159], v179 offset:4096
    s_waitcnt lgkmcnt(4)
    v_mfma_f32_32x32x16_bf16 v[16:31], v[240:243], v[128:131], v[16:31]
    v_mfma_f32_32x32x16_bf16 v[16:31], v[244:247], v[132:135], v[16:31]
    v_mfma_f32_32x32x16_bf16 v[16:31], v[248:251], v[136:139], v[16:31]
    v_mfma_f32_32x32x16_bf16 v[16:31], v[252:255], v[140:143], v[16:31]
    s_waitcnt lgkmcnt(0)
    v_mfma_f32_32x32x16_bf16 v[32:47], v[224:227], v[144:147], v[32:47]
    ds_read_b128 v[128:131], v176 offset:8192
    s_nop 7
    v_pk_mul_f32 v[0:1], v[0:1], s[60:61]
    v_pk_mul_f32 v[2:3], v[2:3], s[60:61]
    v_pk_mul_f32 v[4:5], v[4:5], s[60:61]
    v_pk_mul_f32 v[6:7], v[6:7], s[60:61]
    v_pk_mul_f32 v[8:9], v[8:9], s[60:61]
    v_mfma_f32_32x32x16_bf16 v[32:47], v[228:231], v[148:151], v[32:47]
    ds_read_b128 v[132:135], v177 offset:8192
    v_pk_mul_f32 v[10:11], v[10:11], s[60:61]
    v_pk_mul_f32 v[12:13], v[12:13], s[60:61]
    v_pk_mul_f32 v[14:15], v[14:15], s[60:61]
    v_cvt_pk_bf16_f32 v200, v0, v1
    v_cvt_pk_bf16_f32 v201, v2, v3
    v_cvt_pk_bf16_f32 v202, v4, v5
    v_mfma_f32_32x32x16_bf16 v[32:47], v[232:235], v[152:155], v[32:47]
    ds_read_b128 v[136:139], v178 offset:8192
    v_cvt_pk_bf16_f32 v203, v6, v7
    v_cvt_pk_bf16_f32 v204, v8, v9
    v_cvt_pk_bf16_f32 v205, v10, v11
    v_cvt_pk_bf16_f32 v206, v12, v13
    v_cvt_pk_bf16_f32 v207, v14, v15
    s_mul_i32 s58, s56, 0
    v_mfma_f32_32x32x16_bf16 v[32:47], v[236:239], v[156:159], v[32:47]
    ds_read_b128 v[140:143], v179 offset:8192
    buffer_store_dwordx4 v[200:203], v198, s[24:27], s58 offen sc1
    s_add_u32 s58, s58, s57
    buffer_store_dwordx4 v[204:207], v198, s[24:27], s58 offen sc1
    v_mfma_f32_32x32x16_bf16 v[48:63], v[240:243], v[144:147], v[48:63]
    v_pk_mul_f32 v[16:17], v[16:17], s[60:61]
    v_pk_mul_f32 v[18:19], v[18:19], s[60:61]
    v_pk_mul_f32 v[20:21], v[20:21], s[60:61]
    v_pk_mul_f32 v[22:23], v[22:23], s[60:61]
    v_pk_mul_f32 v[24:25], v[24:25], s[60:61]
    v_mfma_f32_32x32x16_bf16 v[48:63], v[244:247], v[148:151], v[48:63]
    v_pk_mul_f32 v[26:27], v[26:27], s[60:61]
    v_pk_mul_f32 v[28:29], v[28:29], s[60:61]
    v_pk_mul_f32 v[30:31], v[30:31], s[60:61]
    v_cvt_pk_bf16_f32 v208, v16, v17
    v_cvt_pk_bf16_f32 v209, v18, v19
    v_mfma_f32_32x32x16_bf16 v[48:63], v[248:251], v[152:155], v[48:63]
    v_cvt_pk_bf16_f32 v210, v20, v21
    v_cvt_pk_bf16_f32 v211, v22, v23
    v_cvt_pk_bf16_f32 v212, v24, v25
    v_cvt_pk_bf16_f32 v213, v26, v27
    v_cvt_pk_bf16_f32 v214, v28, v29
    v_mfma_f32_32x32x16_bf16 v[48:63], v[252:255], v[156:159], v[48:63]
    v_cvt_pk_bf16_f32 v215, v30, v31
    s_mul_i32 s58, s56, 1
    buffer_store_dwordx4 v[208:211], v198, s[24:27], s58 offen sc1
    s_add_u32 s58, s58, s57
    buffer_store_dwordx4 v[212:215], v198, s[24:27], s58 offen sc1
    s_waitcnt lgkmcnt(0)
    v_mfma_f32_32x32x16_bf16 v[64:79], v[224:227], v[128:131], v[64:79]
    ds_read_b128 v[144:147], v176 offset:12288
    v_pk_mul_f32 v[32:33], v[32:33], s[60:61]
    v_pk_mul_f32 v[34:35], v[34:35], s[60:61]
    v_pk_mul_f32 v[36:37], v[36:37], s[60:61]
    v_pk_mul_f32 v[38:39], v[38:39], s[60:61]
    v_pk_mul_f32 v[40:41], v[40:41], s[60:61]
    v_pk_mul_f32 v[42:43], v[42:43], s[60:61]
    v_mfma_f32_32x32x16_bf16 v[64:79], v[228:231], v[132:135], v[64:79]
    ds_read_b128 v[148:151], v177 offset:12288
    v_pk_mul_f32 v[44:45], v[44:45], s[60:61]
    v_pk_mul_f32 v[46:47], v[46:47], s[60:61]
    v_cvt_pk_bf16_f32 v200, v32, v33
    v_cvt_pk_bf16_f32 v201, v34, v35
    v_cvt_pk_bf16_f32 v202, v36, v37
    v_cvt_pk_bf16_f32 v203, v38, v39
    v_mfma_f32_32x32x16_bf16 v[64:79], v[232:235], v[136:139], v[64:79]
    ds_read_b128 v[152:155], v178 offset:12288
    v_cvt_pk_bf16_f32 v204, v40, v41
    v_cvt_pk_bf16_f32 v205, v42, v43
    v_cvt_pk_bf16_f32 v206, v44, v45
    v_cvt_pk_bf16_f32 v207, v46, v47
    s_mul_i32 s58, s56, 0
    s_add_u32 s58, s58, 40960
    v_mfma_f32_32x32x16_bf16 v[64:79], v[236:239], v[140:143], v[64:79]
    ds_read_b128 v[156:159], v179 offset:12288
    buffer_store_dwordx4 v[200:203], v198, s[24:27], s58 offen sc1
    s_add_u32 s58, s58, s57
    buffer_store_dwordx4 v[204:207], v198, s[24:27], s58 offen sc1
    v_mfma_f32_32x32x16_bf16 v[80:95], v[240:243], v[128:131], v[80:95]
    v_pk_mul_f32 v[48:49], v[48:49], s[60:61]
    v_pk_mul_f32 v[50:51], v[50:51], s[60:61]
    v_pk_mul_f32 v[52:53], v[52:53], s[60:61]
    v_pk_mul_f32 v[54:55], v[54:55], s[60:61]
    v_pk_mul_f32 v[56:57], v[56:57], s[60:61]
    v_pk_mul_f32 v[58:59], v[58:59], s[60:61]
    v_mfma_f32_32x32x16_bf16 v[80:95], v[244:247], v[132:135], v[80:95]
    v_pk_mul_f32 v[60:61], v[60:61], s[60:61]
    v_pk_mul_f32 v[62:63], v[62:63], s[60:61]
    v_cvt_pk_bf16_f32 v208, v48, v49
    v_cvt_pk_bf16_f32 v209, v50, v51
    v_cvt_pk_bf16_f32 v210, v52, v53
    v_cvt_pk_bf16_f32 v211, v54, v55
    v_mfma_f32_32x32x16_bf16 v[80:95], v[248:251], v[136:139], v[80:95]
    v_cvt_pk_bf16_f32 v212, v56, v57
    v_cvt_pk_bf16_f32 v213, v58, v59
    v_cvt_pk_bf16_f32 v214, v60, v61
    v_cvt_pk_bf16_f32 v215, v62, v63
    s_mul_i32 s58, s56, 1
    s_add_u32 s58, s58, 40960
    v_mfma_f32_32x32x16_bf16 v[80:95], v[252:255], v[140:143], v[80:95]
    buffer_store_dwordx4 v[208:211], v198, s[24:27], s58 offen sc1
    s_add_u32 s58, s58, s57
    buffer_store_dwordx4 v[212:215], v198, s[24:27], s58 offen sc1
    s_waitcnt lgkmcnt(0)
    s_barrier
    v_mfma_f32_32x32x16_bf16 v[96:111], v[224:227], v[144:147], v[96:111]
    v_pk_mul_f32 v[64:65], v[64:65], s[60:61]
    v_pk_mul_f32 v[66:67], v[66:67], s[60:61]
    v_pk_mul_f32 v[68:69], v[68:69], s[60:61]
    v_pk_mul_f32 v[70:71], v[70:71], s[60:61]
    v_pk_mul_f32 v[72:73], v[72:73], s[60:61]
    v_pk_mul_f32 v[74:75], v[74:75], s[60:61]
    v_mfma_f32_32x32x16_bf16 v[96:111], v[228:231], v[148:151], v[96:111]
    v_pk_mul_f32 v[76:77], v[76:77], s[60:61]
    v_pk_mul_f32 v[78:79], v[78:79], s[60:61]
    v_cvt_pk_bf16_f32 v200, v64, v65
    v_cvt_pk_bf16_f32 v201, v66, v67
    v_cvt_pk_bf16_f32 v202, v68, v69
    v_cvt_pk_bf16_f32 v203, v70, v71
    v_mfma_f32_32x32x16_bf16 v[96:111], v[232:235], v[152:155], v[96:111]
    v_cvt_pk_bf16_f32 v204, v72, v73
    v_cvt_pk_bf16_f32 v205, v74, v75
    v_cvt_pk_bf16_f32 v206, v76, v77
    v_cvt_pk_bf16_f32 v207, v78, v79
    s_mul_i32 s58, s56, 0
    s_add_u32 s58, s58, 81920
    v_mfma_f32_32x32x16_bf16 v[96:111], v[236:239], v[156:159], v[96:111]
    buffer_store_dwordx4 v[200:203], v198, s[24:27], s58 offen sc1
    s_add_u32 s58, s58, s57
    buffer_store_dwordx4 v[204:207], v198, s[24:27], s58 offen sc1
    v_mfma_f32_32x32x16_bf16 v[112:127], v[240:243], v[144:147], v[112:127]
    v_pk_mul_f32 v[80:81], v[80:81], s[60:61]
    v_pk_mul_f32 v[82:83], v[82:83], s[60:61]
    v_pk_mul_f32 v[84:85], v[84:85], s[60:61]
    v_pk_mul_f32 v[86:87], v[86:87], s[60:61]
    v_pk_mul_f32 v[88:89], v[88:89], s[60:61]
    v_pk_mul_f32 v[90:91], v[90:91], s[60:61]
    v_mfma_f32_32x32x16_bf16 v[112:127], v[244:247], v[148:151], v[112:127]
    v_pk_mul_f32 v[92:93], v[92:93], s[60:61]
    v_pk_mul_f32 v[94:95], v[94:95], s[60:61]
    v_cvt_pk_bf16_f32 v208, v80, v81
    v_cvt_pk_bf16_f32 v209, v82, v83
    v_cvt_pk_bf16_f32 v210, v84, v85
    v_cvt_pk_bf16_f32 v211, v86, v87
    v_mfma_f32_32x32x16_bf16 v[112:127], v[248:251], v[152:155], v[112:127]
    v_cvt_pk_bf16_f32 v212, v88, v89
    v_cvt_pk_bf16_f32 v213, v90, v91
    v_cvt_pk_bf16_f32 v214, v92, v93
    v_cvt_pk_bf16_f32 v215, v94, v95
    s_mul_i32 s58, s56, 1
    s_add_u32 s58, s58, 81920
    v_mfma_f32_32x32x16_bf16 v[112:127], v[252:255], v[156:159], v[112:127]
    buffer_store_dwordx4 v[208:211], v198, s[24:27], s58 offen sc1
    s_add_u32 s58, s58, s57
    buffer_store_dwordx4 v[212:215], v198, s[24:27], s58 offen sc1
    v_pk_mul_f32 v[96:97], v[96:97], s[60:61]
    v_pk_mul_f32 v[98:99], v[98:99], s[60:61]
    v_pk_mul_f32 v[100:101], v[100:101], s[60:61]
    v_pk_mul_f32 v[102:103], v[102:103], s[60:61]
    v_pk_mul_f32 v[104:105], v[104:105], s[60:61]
    v_pk_mul_f32 v[106:107], v[106:107], s[60:61]
    v_pk_mul_f32 v[108:109], v[108:109], s[60:61]
    v_pk_mul_f32 v[110:111], v[110:111], s[60:61]
    v_cvt_pk_bf16_f32 v200, v96, v97
    v_cvt_pk_bf16_f32 v201, v98, v99
    v_cvt_pk_bf16_f32 v202, v100, v101
    v_cvt_pk_bf16_f32 v203, v102, v103
    v_cvt_pk_bf16_f32 v204, v104, v105
    v_cvt_pk_bf16_f32 v205, v106, v107
    v_cvt_pk_bf16_f32 v206, v108, v109
    v_cvt_pk_bf16_f32 v207, v110, v111
    s_mul_i32 s58, s56, 0
    s_add_u32 s58, s58, 122880
    buffer_store_dwordx4 v[200:203], v198, s[24:27], s58 offen sc1
    s_add_u32 s58, s58, s57
    buffer_store_dwordx4 v[204:207], v198, s[24:27], s58 offen sc1
    v_pk_mul_f32 v[112:113], v[112:113], s[60:61]
    v_pk_mul_f32 v[114:115], v[114:115], s[60:61]
    v_pk_mul_f32 v[116:117], v[116:117], s[60:61]
    v_pk_mul_f32 v[118:119], v[118:119], s[60:61]
    v_pk_mul_f32 v[120:121], v[120:121], s[60:61]
    v_pk_mul_f32 v[122:123], v[122:123], s[60:61]
    v_pk_mul_f32 v[124:125], v[124:125], s[60:61]
    v_pk_mul_f32 v[126:127], v[126:127], s[60:61]
    v_cvt_pk_bf16_f32 v208, v112, v113
    v_cvt_pk_bf16_f32 v209, v114, v115
    v_cvt_pk_bf16_f32 v210, v116, v117
    v_cvt_pk_bf16_f32 v211, v118, v119
    v_cvt_pk_bf16_f32 v212, v120, v121
    v_cvt_pk_bf16_f32 v213, v122, v123
    v_cvt_pk_bf16_f32 v214, v124, v125
    v_cvt_pk_bf16_f32 v215, v126, v127
    s_mul_i32 s58, s56, 1
    s_add_u32 s58, s58, 122880
    buffer_store_dwordx4 v[208:211], v198, s[24:27], s58 offen sc1
    s_add_u32 s58, s58, s57
    buffer_store_dwordx4 v[212:215], v198, s[24:27], s58 offen sc1
    s_branch concat_heads__linear_attn_block__sliding_block__prompt_kernel_fin1
concat_heads__linear_attn_block__sliding_block__prompt_kernel_finalF:
    s_cmp_eq_u32 s59, 1
    s_cbranch_scc0 concat_heads__linear_attn_block__sliding_block__prompt_kernel_fin_fn
concat_heads__linear_attn_block__sliding_block__prompt_kernel_fin_fp:
    v_mov_b32 v222, 0
    buffer_load_dwordx2 v[220:221], v222, s[12:15], 0 offen sc1
    s_waitcnt lgkmcnt(0)
    v_mfma_f32_32x32x16_bf16 v[0:15], v[144:147], v[168:171], v[0:15]
    v_mfma_f32_32x32x16_bf16 v[32:47], v[148:151], v[168:171], v[32:47]
    s_barrier
    v_mfma_f32_32x32x16_bf16 v[16:31], v[144:147], v[172:175], v[16:31]
    ds_read_b128 v[128:131], v176
    ds_read_b64_tr_b16 v[224:225], v180 offset:0
    ds_read_b64_tr_b16 v[226:227], v180 offset:1024
    ds_read_b128 v[132:135], v177
    v_mfma_f32_32x32x16_bf16 v[48:63], v[148:151], v[172:175], v[48:63]
    ds_read_b64_tr_b16 v[228:229], v180 offset:4096
    ds_read_b64_tr_b16 v[230:231], v180 offset:5120
    ds_read_b128 v[136:139], v178
    ds_read_b64_tr_b16 v[232:233], v180 offset:8192
    v_mfma_f32_32x32x16_bf16 v[64:79], v[152:155], v[168:171], v[64:79]
    ds_read_b64_tr_b16 v[234:235], v180 offset:9216
    ds_read_b128 v[140:143], v179
    ds_read_b64_tr_b16 v[236:237], v180 offset:12288
    v_mfma_f32_32x32x16_bf16 v[80:95], v[152:155], v[172:175], v[80:95]
    ds_read_b64_tr_b16 v[238:239], v180 offset:13312
    ds_read_b64_tr_b16 v[240:241], v181 offset:0
    ds_read_b64_tr_b16 v[242:243], v181 offset:1024
    v_mfma_f32_32x32x16_bf16 v[96:111], v[156:159], v[168:171], v[96:111]
    ds_read_b64_tr_b16 v[244:245], v181 offset:4096
    ds_read_b64_tr_b16 v[246:247], v181 offset:5120
    ds_read_b64_tr_b16 v[248:249], v181 offset:8192
    v_mfma_f32_32x32x16_bf16 v[112:127], v[156:159], v[172:175], v[112:127]
    ds_read_b64_tr_b16 v[250:251], v181 offset:9216
    ds_read_b64_tr_b16 v[252:253], v181 offset:12288
    ds_read_b64_tr_b16 v[254:255], v181 offset:13312
    s_waitcnt lgkmcnt(8)
    v_mfma_f32_32x32x16_bf16 v[0:15], v[128:131], v[224:227], v[0:15]
    ds_read_b128 v[144:147], v176 offset:4096
    v_mfma_f32_32x32x16_bf16 v[0:15], v[132:135], v[228:231], v[0:15]
    ds_read_b128 v[148:151], v177 offset:4096
    v_mfma_f32_32x32x16_bf16 v[0:15], v[136:139], v[232:235], v[0:15]
    ds_read_b128 v[152:155], v178 offset:4096
    v_mfma_f32_32x32x16_bf16 v[0:15], v[140:143], v[236:239], v[0:15]
    ds_read_b128 v[156:159], v179 offset:4096
    s_waitcnt lgkmcnt(4)
    v_mfma_f32_32x32x16_bf16 v[16:31], v[128:131], v[240:243], v[16:31]
    v_mfma_f32_32x32x16_bf16 v[16:31], v[132:135], v[244:247], v[16:31]
    v_mfma_f32_32x32x16_bf16 v[16:31], v[136:139], v[248:251], v[16:31]
    v_mfma_f32_32x32x16_bf16 v[16:31], v[140:143], v[252:255], v[16:31]
    s_waitcnt lgkmcnt(0)
    v_mfma_f32_32x32x16_bf16 v[32:47], v[144:147], v[224:227], v[32:47]
    ds_read_b128 v[128:131], v176 offset:8192
    s_nop 7
    v_pk_mul_f32 v[216:217], v[0:1], s[60:61]
    v_pk_mul_f32 v[218:219], v[2:3], s[60:61]
    v_exp_f32_e64 v216, v216 clamp
    v_exp_f32_e64 v217, v217 clamp
    v_exp_f32_e64 v218, v218 clamp
    v_exp_f32_e64 v219, v219 clamp
    v_max_f32 v0, s62, v0
    v_max_f32 v1, s62, v1
    v_max_f32 v2, s62, v2
    v_max_f32 v3, s62, v3
    v_pk_add_f32 v[0:1], v[0:1], v[216:217]
    v_pk_add_f32 v[2:3], v[2:3], v[218:219]
    v_cvt_pk_bf16_f32 v200, v0, v1
    v_cvt_pk_bf16_f32 v201, v2, v3
    v_pk_mul_f32 v[216:217], v[4:5], s[60:61]
    v_mfma_f32_32x32x16_bf16 v[32:47], v[148:151], v[228:231], v[32:47]
    ds_read_b128 v[132:135], v177 offset:8192
    v_pk_mul_f32 v[218:219], v[6:7], s[60:61]
    v_exp_f32_e64 v216, v216 clamp
    v_exp_f32_e64 v217, v217 clamp
    v_exp_f32_e64 v218, v218 clamp
    v_exp_f32_e64 v219, v219 clamp
    v_max_f32 v4, s62, v4
    v_max_f32 v5, s62, v5
    v_max_f32 v6, s62, v6
    v_max_f32 v7, s62, v7
    v_pk_add_f32 v[4:5], v[4:5], v[216:217]
    v_pk_add_f32 v[6:7], v[6:7], v[218:219]
    v_cvt_pk_bf16_f32 v202, v4, v5
    v_cvt_pk_bf16_f32 v203, v6, v7
    v_pk_mul_f32 v[216:217], v[8:9], s[60:61]
    v_pk_mul_f32 v[218:219], v[10:11], s[60:61]
    v_exp_f32_e64 v216, v216 clamp
    v_mfma_f32_32x32x16_bf16 v[32:47], v[152:155], v[232:235], v[32:47]
    ds_read_b128 v[136:139], v178 offset:8192
    v_exp_f32_e64 v217, v217 clamp
    v_exp_f32_e64 v218, v218 clamp
    v_exp_f32_e64 v219, v219 clamp
    v_max_f32 v8, s62, v8
    v_max_f32 v9, s62, v9
    v_max_f32 v10, s62, v10
    v_max_f32 v11, s62, v11
    v_pk_add_f32 v[8:9], v[8:9], v[216:217]
    v_pk_add_f32 v[10:11], v[10:11], v[218:219]
    v_cvt_pk_bf16_f32 v204, v8, v9
    v_cvt_pk_bf16_f32 v205, v10, v11
    v_pk_mul_f32 v[216:217], v[12:13], s[60:61]
    v_pk_mul_f32 v[218:219], v[14:15], s[60:61]
    v_exp_f32_e64 v216, v216 clamp
    v_exp_f32_e64 v217, v217 clamp
    v_exp_f32_e64 v218, v218 clamp
    v_mfma_f32_32x32x16_bf16 v[32:47], v[156:159], v[236:239], v[32:47]
    ds_read_b128 v[140:143], v179 offset:8192
    v_exp_f32_e64 v219, v219 clamp
    v_max_f32 v12, s62, v12
    v_max_f32 v13, s62, v13
    v_max_f32 v14, s62, v14
    v_max_f32 v15, s62, v15
    v_pk_add_f32 v[12:13], v[12:13], v[216:217]
    v_pk_add_f32 v[14:15], v[14:15], v[218:219]
    v_cvt_pk_bf16_f32 v206, v12, v13
    v_cvt_pk_bf16_f32 v207, v14, v15
    s_mul_i32 s58, s56, 0
    buffer_store_dwordx4 v[200:203], v198, s[24:27], s58 offen sc1
    s_add_u32 s58, s58, s57
    buffer_store_dwordx4 v[204:207], v198, s[24:27], s58 offen sc1
    v_mfma_f32_32x32x16_bf16 v[48:63], v[144:147], v[240:243], v[48:63]
    v_pk_mul_f32 v[216:217], v[16:17], s[60:61]
    v_pk_mul_f32 v[218:219], v[18:19], s[60:61]
    v_exp_f32_e64 v216, v216 clamp
    v_exp_f32_e64 v217, v217 clamp
    v_exp_f32_e64 v218, v218 clamp
    v_exp_f32_e64 v219, v219 clamp
    v_max_f32 v16, s62, v16
    v_max_f32 v17, s62, v17
    v_max_f32 v18, s62, v18
    v_max_f32 v19, s62, v19
    v_pk_add_f32 v[16:17], v[16:17], v[216:217]
    v_pk_add_f32 v[18:19], v[18:19], v[218:219]
    v_cvt_pk_bf16_f32 v208, v16, v17
    v_cvt_pk_bf16_f32 v209, v18, v19
    v_pk_mul_f32 v[216:217], v[20:21], s[60:61]
    v_mfma_f32_32x32x16_bf16 v[48:63], v[148:151], v[244:247], v[48:63]
    v_pk_mul_f32 v[218:219], v[22:23], s[60:61]
    v_exp_f32_e64 v216, v216 clamp
    v_exp_f32_e64 v217, v217 clamp
    v_exp_f32_e64 v218, v218 clamp
    v_exp_f32_e64 v219, v219 clamp
    v_max_f32 v20, s62, v20
    v_max_f32 v21, s62, v21
    v_max_f32 v22, s62, v22
    v_max_f32 v23, s62, v23
    v_pk_add_f32 v[20:21], v[20:21], v[216:217]
    v_pk_add_f32 v[22:23], v[22:23], v[218:219]
    v_cvt_pk_bf16_f32 v210, v20, v21
    v_cvt_pk_bf16_f32 v211, v22, v23
    v_pk_mul_f32 v[216:217], v[24:25], s[60:61]
    v_pk_mul_f32 v[218:219], v[26:27], s[60:61]
    v_mfma_f32_32x32x16_bf16 v[48:63], v[152:155], v[248:251], v[48:63]
    v_exp_f32_e64 v216, v216 clamp
    v_exp_f32_e64 v217, v217 clamp
    v_exp_f32_e64 v218, v218 clamp
    v_exp_f32_e64 v219, v219 clamp
    v_max_f32 v24, s62, v24
    v_max_f32 v25, s62, v25
    v_max_f32 v26, s62, v26
    v_max_f32 v27, s62, v27
    v_pk_add_f32 v[24:25], v[24:25], v[216:217]
    v_pk_add_f32 v[26:27], v[26:27], v[218:219]
    v_cvt_pk_bf16_f32 v212, v24, v25
    v_cvt_pk_bf16_f32 v213, v26, v27
    v_pk_mul_f32 v[216:217], v[28:29], s[60:61]
    v_pk_mul_f32 v[218:219], v[30:31], s[60:61]
    v_exp_f32_e64 v216, v216 clamp
    v_mfma_f32_32x32x16_bf16 v[48:63], v[156:159], v[252:255], v[48:63]
    v_exp_f32_e64 v217, v217 clamp
    v_exp_f32_e64 v218, v218 clamp
    v_exp_f32_e64 v219, v219 clamp
    v_max_f32 v28, s62, v28
    v_max_f32 v29, s62, v29
    v_max_f32 v30, s62, v30
    v_max_f32 v31, s62, v31
    v_pk_add_f32 v[28:29], v[28:29], v[216:217]
    v_pk_add_f32 v[30:31], v[30:31], v[218:219]
    v_cvt_pk_bf16_f32 v214, v28, v29
    v_cvt_pk_bf16_f32 v215, v30, v31
    s_mul_i32 s58, s56, 1
    buffer_store_dwordx4 v[208:211], v198, s[24:27], s58 offen sc1
    s_add_u32 s58, s58, s57
    buffer_store_dwordx4 v[212:215], v198, s[24:27], s58 offen sc1
    s_waitcnt lgkmcnt(0)
    v_mfma_f32_32x32x16_bf16 v[64:79], v[128:131], v[224:227], v[64:79]
    ds_read_b128 v[144:147], v176 offset:12288
    v_pk_mul_f32 v[216:217], v[32:33], s[60:61]
    v_pk_mul_f32 v[218:219], v[34:35], s[60:61]
    v_exp_f32_e64 v216, v216 clamp
    v_exp_f32_e64 v217, v217 clamp
    v_exp_f32_e64 v218, v218 clamp
    v_exp_f32_e64 v219, v219 clamp
    v_max_f32 v32, s62, v32
    v_max_f32 v33, s62, v33
    v_max_f32 v34, s62, v34
    v_max_f32 v35, s62, v35
    v_pk_add_f32 v[32:33], v[32:33], v[216:217]
    v_pk_add_f32 v[34:35], v[34:35], v[218:219]
    v_cvt_pk_bf16_f32 v200, v32, v33
    v_cvt_pk_bf16_f32 v201, v34, v35
    v_pk_mul_f32 v[216:217], v[36:37], s[60:61]
    v_pk_mul_f32 v[218:219], v[38:39], s[60:61]
    v_mfma_f32_32x32x16_bf16 v[64:79], v[132:135], v[228:231], v[64:79]
    ds_read_b128 v[148:151], v177 offset:12288
    v_exp_f32_e64 v216, v216 clamp
    v_exp_f32_e64 v217, v217 clamp
    v_exp_f32_e64 v218, v218 clamp
    v_exp_f32_e64 v219, v219 clamp
    v_max_f32 v36, s62, v36
    v_max_f32 v37, s62, v37
    v_max_f32 v38, s62, v38
    v_max_f32 v39, s62, v39
    v_pk_add_f32 v[36:37], v[36:37], v[216:217]
    v_pk_add_f32 v[38:39], v[38:39], v[218:219]
    v_cvt_pk_bf16_f32 v202, v36, v37
    v_cvt_pk_bf16_f32 v203, v38, v39
    v_pk_mul_f32 v[216:217], v[40:41], s[60:61]
    v_pk_mul_f32 v[218:219], v[42:43], s[60:61]
    v_exp_f32_e64 v216, v216 clamp
    v_exp_f32_e64 v217, v217 clamp
    v_mfma_f32_32x32x16_bf16 v[64:79], v[136:139], v[232:235], v[64:79]
    ds_read_b128 v[152:155], v178 offset:12288
    v_exp_f32_e64 v218, v218 clamp
    v_exp_f32_e64 v219, v219 clamp
    v_max_f32 v40, s62, v40
    v_max_f32 v41, s62, v41
    v_max_f32 v42, s62, v42
    v_max_f32 v43, s62, v43
    v_pk_add_f32 v[40:41], v[40:41], v[216:217]
    v_pk_add_f32 v[42:43], v[42:43], v[218:219]
    v_cvt_pk_bf16_f32 v204, v40, v41
    v_cvt_pk_bf16_f32 v205, v42, v43
    v_pk_mul_f32 v[216:217], v[44:45], s[60:61]
    v_pk_mul_f32 v[218:219], v[46:47], s[60:61]
    v_exp_f32_e64 v216, v216 clamp
    v_exp_f32_e64 v217, v217 clamp
    v_exp_f32_e64 v218, v218 clamp
    v_exp_f32_e64 v219, v219 clamp
    v_mfma_f32_32x32x16_bf16 v[64:79], v[140:143], v[236:239], v[64:79]
    ds_read_b128 v[156:159], v179 offset:12288
    v_max_f32 v44, s62, v44
    v_max_f32 v45, s62, v45
    v_max_f32 v46, s62, v46
    v_max_f32 v47, s62, v47
    v_pk_add_f32 v[44:45], v[44:45], v[216:217]
    v_pk_add_f32 v[46:47], v[46:47], v[218:219]
    v_cvt_pk_bf16_f32 v206, v44, v45
    v_cvt_pk_bf16_f32 v207, v46, v47
    s_mul_i32 s58, s56, 0
    s_add_u32 s58, s58, 40960
    buffer_store_dwordx4 v[200:203], v198, s[24:27], s58 offen sc1
    s_add_u32 s58, s58, s57
    buffer_store_dwordx4 v[204:207], v198, s[24:27], s58 offen sc1
    v_mfma_f32_32x32x16_bf16 v[80:95], v[128:131], v[240:243], v[80:95]
    v_pk_mul_f32 v[216:217], v[48:49], s[60:61]
    v_pk_mul_f32 v[218:219], v[50:51], s[60:61]
    v_exp_f32_e64 v216, v216 clamp
    v_exp_f32_e64 v217, v217 clamp
    v_exp_f32_e64 v218, v218 clamp
    v_exp_f32_e64 v219, v219 clamp
    v_max_f32 v48, s62, v48
    v_max_f32 v49, s62, v49
    v_max_f32 v50, s62, v50
    v_max_f32 v51, s62, v51
    v_pk_add_f32 v[48:49], v[48:49], v[216:217]
    v_pk_add_f32 v[50:51], v[50:51], v[218:219]
    v_cvt_pk_bf16_f32 v208, v48, v49
    v_cvt_pk_bf16_f32 v209, v50, v51
    v_pk_mul_f32 v[216:217], v[52:53], s[60:61]
    v_pk_mul_f32 v[218:219], v[54:55], s[60:61]
    v_mfma_f32_32x32x16_bf16 v[80:95], v[132:135], v[244:247], v[80:95]
    v_exp_f32_e64 v216, v216 clamp
    v_exp_f32_e64 v217, v217 clamp
    v_exp_f32_e64 v218, v218 clamp
    v_exp_f32_e64 v219, v219 clamp
    v_max_f32 v52, s62, v52
    v_max_f32 v53, s62, v53
    v_max_f32 v54, s62, v54
    v_max_f32 v55, s62, v55
    v_pk_add_f32 v[52:53], v[52:53], v[216:217]
    v_pk_add_f32 v[54:55], v[54:55], v[218:219]
    v_cvt_pk_bf16_f32 v210, v52, v53
    v_cvt_pk_bf16_f32 v211, v54, v55
    v_pk_mul_f32 v[216:217], v[56:57], s[60:61]
    v_pk_mul_f32 v[218:219], v[58:59], s[60:61]
    v_exp_f32_e64 v216, v216 clamp
    v_exp_f32_e64 v217, v217 clamp
    v_mfma_f32_32x32x16_bf16 v[80:95], v[136:139], v[248:251], v[80:95]
    v_exp_f32_e64 v218, v218 clamp
    v_exp_f32_e64 v219, v219 clamp
    v_max_f32 v56, s62, v56
    v_max_f32 v57, s62, v57
    v_max_f32 v58, s62, v58
    v_max_f32 v59, s62, v59
    v_pk_add_f32 v[56:57], v[56:57], v[216:217]
    v_pk_add_f32 v[58:59], v[58:59], v[218:219]
    v_cvt_pk_bf16_f32 v212, v56, v57
    v_cvt_pk_bf16_f32 v213, v58, v59
    v_pk_mul_f32 v[216:217], v[60:61], s[60:61]
    v_pk_mul_f32 v[218:219], v[62:63], s[60:61]
    v_exp_f32_e64 v216, v216 clamp
    v_exp_f32_e64 v217, v217 clamp
    v_exp_f32_e64 v218, v218 clamp
    v_exp_f32_e64 v219, v219 clamp
    v_mfma_f32_32x32x16_bf16 v[80:95], v[140:143], v[252:255], v[80:95]
    v_max_f32 v60, s62, v60
    v_max_f32 v61, s62, v61
    v_max_f32 v62, s62, v62
    v_max_f32 v63, s62, v63
    v_pk_add_f32 v[60:61], v[60:61], v[216:217]
    v_pk_add_f32 v[62:63], v[62:63], v[218:219]
    v_cvt_pk_bf16_f32 v214, v60, v61
    v_cvt_pk_bf16_f32 v215, v62, v63
    s_mul_i32 s58, s56, 1
    s_add_u32 s58, s58, 40960
    buffer_store_dwordx4 v[208:211], v198, s[24:27], s58 offen sc1
    s_add_u32 s58, s58, s57
    buffer_store_dwordx4 v[212:215], v198, s[24:27], s58 offen sc1
    s_waitcnt lgkmcnt(0)
    s_barrier
    v_mfma_f32_32x32x16_bf16 v[96:111], v[144:147], v[224:227], v[96:111]
    v_pk_mul_f32 v[216:217], v[64:65], s[60:61]
    v_pk_mul_f32 v[218:219], v[66:67], s[60:61]
    v_exp_f32_e64 v216, v216 clamp
    v_exp_f32_e64 v217, v217 clamp
    v_exp_f32_e64 v218, v218 clamp
    v_exp_f32_e64 v219, v219 clamp
    v_max_f32 v64, s62, v64
    v_max_f32 v65, s62, v65
    v_max_f32 v66, s62, v66
    v_max_f32 v67, s62, v67
    v_pk_add_f32 v[64:65], v[64:65], v[216:217]
    v_pk_add_f32 v[66:67], v[66:67], v[218:219]
    v_cvt_pk_bf16_f32 v200, v64, v65
    v_cvt_pk_bf16_f32 v201, v66, v67
    v_pk_mul_f32 v[216:217], v[68:69], s[60:61]
    v_pk_mul_f32 v[218:219], v[70:71], s[60:61]
    v_mfma_f32_32x32x16_bf16 v[96:111], v[148:151], v[228:231], v[96:111]
    v_exp_f32_e64 v216, v216 clamp
    v_exp_f32_e64 v217, v217 clamp
    v_exp_f32_e64 v218, v218 clamp
    v_exp_f32_e64 v219, v219 clamp
    v_max_f32 v68, s62, v68
    v_max_f32 v69, s62, v69
    v_max_f32 v70, s62, v70
    v_max_f32 v71, s62, v71
    v_pk_add_f32 v[68:69], v[68:69], v[216:217]
    v_pk_add_f32 v[70:71], v[70:71], v[218:219]
    v_cvt_pk_bf16_f32 v202, v68, v69
    v_cvt_pk_bf16_f32 v203, v70, v71
    v_pk_mul_f32 v[216:217], v[72:73], s[60:61]
    v_pk_mul_f32 v[218:219], v[74:75], s[60:61]
    v_exp_f32_e64 v216, v216 clamp
    v_exp_f32_e64 v217, v217 clamp
    v_mfma_f32_32x32x16_bf16 v[96:111], v[152:155], v[232:235], v[96:111]
    v_exp_f32_e64 v218, v218 clamp
    v_exp_f32_e64 v219, v219 clamp
    v_max_f32 v72, s62, v72
    v_max_f32 v73, s62, v73
    v_max_f32 v74, s62, v74
    v_max_f32 v75, s62, v75
    v_pk_add_f32 v[72:73], v[72:73], v[216:217]
    v_pk_add_f32 v[74:75], v[74:75], v[218:219]
    v_cvt_pk_bf16_f32 v204, v72, v73
    v_cvt_pk_bf16_f32 v205, v74, v75
    v_pk_mul_f32 v[216:217], v[76:77], s[60:61]
    v_pk_mul_f32 v[218:219], v[78:79], s[60:61]
    v_exp_f32_e64 v216, v216 clamp
    v_exp_f32_e64 v217, v217 clamp
    v_exp_f32_e64 v218, v218 clamp
    v_exp_f32_e64 v219, v219 clamp
    v_mfma_f32_32x32x16_bf16 v[96:111], v[156:159], v[236:239], v[96:111]
    v_max_f32 v76, s62, v76
    v_max_f32 v77, s62, v77
    v_max_f32 v78, s62, v78
    v_max_f32 v79, s62, v79
    v_pk_add_f32 v[76:77], v[76:77], v[216:217]
    v_pk_add_f32 v[78:79], v[78:79], v[218:219]
    v_cvt_pk_bf16_f32 v206, v76, v77
    v_cvt_pk_bf16_f32 v207, v78, v79
    s_mul_i32 s58, s56, 0
    s_add_u32 s58, s58, 81920
    buffer_store_dwordx4 v[200:203], v198, s[24:27], s58 offen sc1
    s_add_u32 s58, s58, s57
    buffer_store_dwordx4 v[204:207], v198, s[24:27], s58 offen sc1
    v_mfma_f32_32x32x16_bf16 v[112:127], v[144:147], v[240:243], v[112:127]
    v_pk_mul_f32 v[216:217], v[80:81], s[60:61]
    v_pk_mul_f32 v[218:219], v[82:83], s[60:61]
    v_exp_f32_e64 v216, v216 clamp
    v_exp_f32_e64 v217, v217 clamp
    v_exp_f32_e64 v218, v218 clamp
    v_exp_f32_e64 v219, v219 clamp
    v_max_f32 v80, s62, v80
    v_max_f32 v81, s62, v81
    v_max_f32 v82, s62, v82
    v_max_f32 v83, s62, v83
    v_pk_add_f32 v[80:81], v[80:81], v[216:217]
    v_pk_add_f32 v[82:83], v[82:83], v[218:219]
    v_cvt_pk_bf16_f32 v208, v80, v81
    v_cvt_pk_bf16_f32 v209, v82, v83
    v_pk_mul_f32 v[216:217], v[84:85], s[60:61]
    v_pk_mul_f32 v[218:219], v[86:87], s[60:61]
    v_mfma_f32_32x32x16_bf16 v[112:127], v[148:151], v[244:247], v[112:127]
    v_exp_f32_e64 v216, v216 clamp
    v_exp_f32_e64 v217, v217 clamp
    v_exp_f32_e64 v218, v218 clamp
    v_exp_f32_e64 v219, v219 clamp
    v_max_f32 v84, s62, v84
    v_max_f32 v85, s62, v85
    v_max_f32 v86, s62, v86
    v_max_f32 v87, s62, v87
    v_pk_add_f32 v[84:85], v[84:85], v[216:217]
    v_pk_add_f32 v[86:87], v[86:87], v[218:219]
    v_cvt_pk_bf16_f32 v210, v84, v85
    v_cvt_pk_bf16_f32 v211, v86, v87
    v_pk_mul_f32 v[216:217], v[88:89], s[60:61]
    v_pk_mul_f32 v[218:219], v[90:91], s[60:61]
    v_exp_f32_e64 v216, v216 clamp
    v_exp_f32_e64 v217, v217 clamp
    v_mfma_f32_32x32x16_bf16 v[112:127], v[152:155], v[248:251], v[112:127]
    v_exp_f32_e64 v218, v218 clamp
    v_exp_f32_e64 v219, v219 clamp
    v_max_f32 v88, s62, v88
    v_max_f32 v89, s62, v89
    v_max_f32 v90, s62, v90
    v_max_f32 v91, s62, v91
    v_pk_add_f32 v[88:89], v[88:89], v[216:217]
    v_pk_add_f32 v[90:91], v[90:91], v[218:219]
    v_cvt_pk_bf16_f32 v212, v88, v89
    v_cvt_pk_bf16_f32 v213, v90, v91
    v_pk_mul_f32 v[216:217], v[92:93], s[60:61]
    v_pk_mul_f32 v[218:219], v[94:95], s[60:61]
    v_exp_f32_e64 v216, v216 clamp
    v_exp_f32_e64 v217, v217 clamp
    v_exp_f32_e64 v218, v218 clamp
    v_exp_f32_e64 v219, v219 clamp
    v_mfma_f32_32x32x16_bf16 v[112:127], v[156:159], v[252:255], v[112:127]
    v_max_f32 v92, s62, v92
    v_max_f32 v93, s62, v93
    v_max_f32 v94, s62, v94
    v_max_f32 v95, s62, v95
    v_pk_add_f32 v[92:93], v[92:93], v[216:217]
    v_pk_add_f32 v[94:95], v[94:95], v[218:219]
    v_cvt_pk_bf16_f32 v214, v92, v93
    v_cvt_pk_bf16_f32 v215, v94, v95
    s_mul_i32 s58, s56, 1
    s_add_u32 s58, s58, 81920
    buffer_store_dwordx4 v[208:211], v198, s[24:27], s58 offen sc1
    s_add_u32 s58, s58, s57
    buffer_store_dwordx4 v[212:215], v198, s[24:27], s58 offen sc1
    v_pk_mul_f32 v[216:217], v[96:97], s[60:61]
    v_pk_mul_f32 v[218:219], v[98:99], s[60:61]
    v_exp_f32_e64 v216, v216 clamp
    v_exp_f32_e64 v217, v217 clamp
    v_exp_f32_e64 v218, v218 clamp
    v_exp_f32_e64 v219, v219 clamp
    v_max_f32 v96, s62, v96
    v_max_f32 v97, s62, v97
    v_max_f32 v98, s62, v98
    v_max_f32 v99, s62, v99
    v_pk_add_f32 v[96:97], v[96:97], v[216:217]
    v_pk_add_f32 v[98:99], v[98:99], v[218:219]
    v_cvt_pk_bf16_f32 v200, v96, v97
    v_cvt_pk_bf16_f32 v201, v98, v99
    v_pk_mul_f32 v[216:217], v[100:101], s[60:61]
    v_pk_mul_f32 v[218:219], v[102:103], s[60:61]
    v_exp_f32_e64 v216, v216 clamp
    v_exp_f32_e64 v217, v217 clamp
    v_exp_f32_e64 v218, v218 clamp
    v_exp_f32_e64 v219, v219 clamp
    v_max_f32 v100, s62, v100
    v_max_f32 v101, s62, v101
    v_max_f32 v102, s62, v102
    v_max_f32 v103, s62, v103
    v_pk_add_f32 v[100:101], v[100:101], v[216:217]
    v_pk_add_f32 v[102:103], v[102:103], v[218:219]
    v_cvt_pk_bf16_f32 v202, v100, v101
    v_cvt_pk_bf16_f32 v203, v102, v103
    v_pk_mul_f32 v[216:217], v[104:105], s[60:61]
    v_pk_mul_f32 v[218:219], v[106:107], s[60:61]
    v_exp_f32_e64 v216, v216 clamp
    v_exp_f32_e64 v217, v217 clamp
    v_exp_f32_e64 v218, v218 clamp
    v_exp_f32_e64 v219, v219 clamp
    v_max_f32 v104, s62, v104
    v_max_f32 v105, s62, v105
    v_max_f32 v106, s62, v106
    v_max_f32 v107, s62, v107
    v_pk_add_f32 v[104:105], v[104:105], v[216:217]
    v_pk_add_f32 v[106:107], v[106:107], v[218:219]
    v_cvt_pk_bf16_f32 v204, v104, v105
    v_cvt_pk_bf16_f32 v205, v106, v107
    v_pk_mul_f32 v[216:217], v[108:109], s[60:61]
    v_pk_mul_f32 v[218:219], v[110:111], s[60:61]
    v_exp_f32_e64 v216, v216 clamp
    v_exp_f32_e64 v217, v217 clamp
    v_exp_f32_e64 v218, v218 clamp
    v_exp_f32_e64 v219, v219 clamp
    v_max_f32 v108, s62, v108
    v_max_f32 v109, s62, v109
    v_max_f32 v110, s62, v110
    v_max_f32 v111, s62, v111
    v_pk_add_f32 v[108:109], v[108:109], v[216:217]
    v_pk_add_f32 v[110:111], v[110:111], v[218:219]
    v_cvt_pk_bf16_f32 v206, v108, v109
    v_cvt_pk_bf16_f32 v207, v110, v111
    s_mul_i32 s58, s56, 0
    s_add_u32 s58, s58, 122880
    buffer_store_dwordx4 v[200:203], v198, s[24:27], s58 offen sc1
    s_add_u32 s58, s58, s57
    buffer_store_dwordx4 v[204:207], v198, s[24:27], s58 offen sc1
    v_pk_mul_f32 v[216:217], v[112:113], s[60:61]
    v_pk_mul_f32 v[218:219], v[114:115], s[60:61]
    v_exp_f32_e64 v216, v216 clamp
    v_exp_f32_e64 v217, v217 clamp
    v_exp_f32_e64 v218, v218 clamp
    v_exp_f32_e64 v219, v219 clamp
    v_max_f32 v112, s62, v112
    v_max_f32 v113, s62, v113
    v_max_f32 v114, s62, v114
    v_max_f32 v115, s62, v115
    v_pk_add_f32 v[112:113], v[112:113], v[216:217]
    v_pk_add_f32 v[114:115], v[114:115], v[218:219]
    v_cvt_pk_bf16_f32 v208, v112, v113
    v_cvt_pk_bf16_f32 v209, v114, v115
    v_pk_mul_f32 v[216:217], v[116:117], s[60:61]
    v_pk_mul_f32 v[218:219], v[118:119], s[60:61]
    v_exp_f32_e64 v216, v216 clamp
    v_exp_f32_e64 v217, v217 clamp
    v_exp_f32_e64 v218, v218 clamp
    v_exp_f32_e64 v219, v219 clamp
    v_max_f32 v116, s62, v116
    v_max_f32 v117, s62, v117
    v_max_f32 v118, s62, v118
    v_max_f32 v119, s62, v119
    v_pk_add_f32 v[116:117], v[116:117], v[216:217]
    v_pk_add_f32 v[118:119], v[118:119], v[218:219]
    v_cvt_pk_bf16_f32 v210, v116, v117
    v_cvt_pk_bf16_f32 v211, v118, v119
    v_pk_mul_f32 v[216:217], v[120:121], s[60:61]
    v_pk_mul_f32 v[218:219], v[122:123], s[60:61]
    v_exp_f32_e64 v216, v216 clamp
    v_exp_f32_e64 v217, v217 clamp
    v_exp_f32_e64 v218, v218 clamp
    v_exp_f32_e64 v219, v219 clamp
    v_max_f32 v120, s62, v120
    v_max_f32 v121, s62, v121
    v_max_f32 v122, s62, v122
    v_max_f32 v123, s62, v123
    v_pk_add_f32 v[120:121], v[120:121], v[216:217]
    v_pk_add_f32 v[122:123], v[122:123], v[218:219]
    v_cvt_pk_bf16_f32 v212, v120, v121
    v_cvt_pk_bf16_f32 v213, v122, v123
    v_pk_mul_f32 v[216:217], v[124:125], s[60:61]
    v_pk_mul_f32 v[218:219], v[126:127], s[60:61]
    v_exp_f32_e64 v216, v216 clamp
    v_exp_f32_e64 v217, v217 clamp
    v_exp_f32_e64 v218, v218 clamp
    v_exp_f32_e64 v219, v219 clamp
    v_max_f32 v124, s62, v124
    v_max_f32 v125, s62, v125
    v_max_f32 v126, s62, v126
    v_max_f32 v127, s62, v127
    v_pk_add_f32 v[124:125], v[124:125], v[216:217]
    v_pk_add_f32 v[126:127], v[126:127], v[218:219]
    v_cvt_pk_bf16_f32 v214, v124, v125
    v_cvt_pk_bf16_f32 v215, v126, v127
    s_mul_i32 s58, s56, 1
    s_add_u32 s58, s58, 122880
    buffer_store_dwordx4 v[208:211], v198, s[24:27], s58 offen sc1
    s_add_u32 s58, s58, s57
    buffer_store_dwordx4 v[212:215], v198, s[24:27], s58 offen sc1
    s_branch concat_heads__linear_attn_block__sliding_block__prompt_kernel_fin1
concat_heads__linear_attn_block__sliding_block__prompt_kernel_fin_fn:
    v_mov_b32 v222, 0
    buffer_load_dwordx2 v[220:221], v222, s[12:15], 0 offen sc1
    s_waitcnt lgkmcnt(0)
    v_mfma_f32_32x32x16_bf16 v[0:15], v[144:147], v[168:171], v[0:15]
    v_mfma_f32_32x32x16_bf16 v[32:47], v[148:151], v[168:171], v[32:47]
    s_barrier
    v_mfma_f32_32x32x16_bf16 v[16:31], v[144:147], v[172:175], v[16:31]
    ds_read_b128 v[128:131], v176
    ds_read_b64_tr_b16 v[224:225], v180 offset:0
    ds_read_b64_tr_b16 v[226:227], v180 offset:1024
    ds_read_b128 v[132:135], v177
    v_mfma_f32_32x32x16_bf16 v[48:63], v[148:151], v[172:175], v[48:63]
    ds_read_b64_tr_b16 v[228:229], v180 offset:4096
    ds_read_b64_tr_b16 v[230:231], v180 offset:5120
    ds_read_b128 v[136:139], v178
    ds_read_b64_tr_b16 v[232:233], v180 offset:8192
    v_mfma_f32_32x32x16_bf16 v[64:79], v[152:155], v[168:171], v[64:79]
    ds_read_b64_tr_b16 v[234:235], v180 offset:9216
    ds_read_b128 v[140:143], v179
    ds_read_b64_tr_b16 v[236:237], v180 offset:12288
    v_mfma_f32_32x32x16_bf16 v[80:95], v[152:155], v[172:175], v[80:95]
    ds_read_b64_tr_b16 v[238:239], v180 offset:13312
    ds_read_b64_tr_b16 v[240:241], v181 offset:0
    ds_read_b64_tr_b16 v[242:243], v181 offset:1024
    v_mfma_f32_32x32x16_bf16 v[96:111], v[156:159], v[168:171], v[96:111]
    ds_read_b64_tr_b16 v[244:245], v181 offset:4096
    ds_read_b64_tr_b16 v[246:247], v181 offset:5120
    ds_read_b64_tr_b16 v[248:249], v181 offset:8192
    v_mfma_f32_32x32x16_bf16 v[112:127], v[156:159], v[172:175], v[112:127]
    ds_read_b64_tr_b16 v[250:251], v181 offset:9216
    ds_read_b64_tr_b16 v[252:253], v181 offset:12288
    ds_read_b64_tr_b16 v[254:255], v181 offset:13312
    s_waitcnt lgkmcnt(8)
    v_mfma_f32_32x32x16_bf16 v[0:15], v[128:131], v[224:227], v[0:15]
    ds_read_b128 v[144:147], v176 offset:4096
    v_mfma_f32_32x32x16_bf16 v[0:15], v[132:135], v[228:231], v[0:15]
    ds_read_b128 v[148:151], v177 offset:4096
    v_mfma_f32_32x32x16_bf16 v[0:15], v[136:139], v[232:235], v[0:15]
    ds_read_b128 v[152:155], v178 offset:4096
    v_mfma_f32_32x32x16_bf16 v[0:15], v[140:143], v[236:239], v[0:15]
    ds_read_b128 v[156:159], v179 offset:4096
    s_waitcnt lgkmcnt(4)
    v_mfma_f32_32x32x16_bf16 v[16:31], v[128:131], v[240:243], v[16:31]
    v_mfma_f32_32x32x16_bf16 v[16:31], v[132:135], v[244:247], v[16:31]
    v_mfma_f32_32x32x16_bf16 v[16:31], v[136:139], v[248:251], v[16:31]
    v_mfma_f32_32x32x16_bf16 v[16:31], v[140:143], v[252:255], v[16:31]
    s_waitcnt lgkmcnt(0)
    v_mfma_f32_32x32x16_bf16 v[32:47], v[144:147], v[224:227], v[32:47]
    ds_read_b128 v[128:131], v176 offset:8192
    s_nop 7
    v_cvt_pk_bf16_f32 v200, v0, v1
    v_cvt_pk_bf16_f32 v201, v2, v3
    v_cvt_pk_bf16_f32 v202, v4, v5
    v_mfma_f32_32x32x16_bf16 v[32:47], v[148:151], v[228:231], v[32:47]
    ds_read_b128 v[132:135], v177 offset:8192
    v_cvt_pk_bf16_f32 v203, v6, v7
    v_cvt_pk_bf16_f32 v204, v8, v9
    v_cvt_pk_bf16_f32 v205, v10, v11
    v_cvt_pk_bf16_f32 v206, v12, v13
    v_mfma_f32_32x32x16_bf16 v[32:47], v[152:155], v[232:235], v[32:47]
    ds_read_b128 v[136:139], v178 offset:8192
    v_cvt_pk_bf16_f32 v207, v14, v15
    s_mul_i32 s58, s56, 0
    buffer_store_dwordx4 v[200:203], v198, s[24:27], s58 offen sc1
    s_add_u32 s58, s58, s57
    v_mfma_f32_32x32x16_bf16 v[32:47], v[156:159], v[236:239], v[32:47]
    ds_read_b128 v[140:143], v179 offset:8192
    buffer_store_dwordx4 v[204:207], v198, s[24:27], s58 offen sc1
    v_mfma_f32_32x32x16_bf16 v[48:63], v[144:147], v[240:243], v[48:63]
    v_cvt_pk_bf16_f32 v208, v16, v17
    v_cvt_pk_bf16_f32 v209, v18, v19
    v_cvt_pk_bf16_f32 v210, v20, v21
    v_mfma_f32_32x32x16_bf16 v[48:63], v[148:151], v[244:247], v[48:63]
    v_cvt_pk_bf16_f32 v211, v22, v23
    v_cvt_pk_bf16_f32 v212, v24, v25
    v_cvt_pk_bf16_f32 v213, v26, v27
    v_mfma_f32_32x32x16_bf16 v[48:63], v[152:155], v[248:251], v[48:63]
    v_cvt_pk_bf16_f32 v214, v28, v29
    v_cvt_pk_bf16_f32 v215, v30, v31
    s_mul_i32 s58, s56, 1
    v_mfma_f32_32x32x16_bf16 v[48:63], v[156:159], v[252:255], v[48:63]
    buffer_store_dwordx4 v[208:211], v198, s[24:27], s58 offen sc1
    s_add_u32 s58, s58, s57
    buffer_store_dwordx4 v[212:215], v198, s[24:27], s58 offen sc1
    s_waitcnt lgkmcnt(0)
    v_mfma_f32_32x32x16_bf16 v[64:79], v[128:131], v[224:227], v[64:79]
    ds_read_b128 v[144:147], v176 offset:12288
    v_cvt_pk_bf16_f32 v200, v32, v33
    v_cvt_pk_bf16_f32 v201, v34, v35
    v_cvt_pk_bf16_f32 v202, v36, v37
    v_cvt_pk_bf16_f32 v203, v38, v39
    v_mfma_f32_32x32x16_bf16 v[64:79], v[132:135], v[228:231], v[64:79]
    ds_read_b128 v[148:151], v177 offset:12288
    v_cvt_pk_bf16_f32 v204, v40, v41
    v_cvt_pk_bf16_f32 v205, v42, v43
    v_cvt_pk_bf16_f32 v206, v44, v45
    v_cvt_pk_bf16_f32 v207, v46, v47
    v_mfma_f32_32x32x16_bf16 v[64:79], v[136:139], v[232:235], v[64:79]
    ds_read_b128 v[152:155], v178 offset:12288
    s_mul_i32 s58, s56, 0
    s_add_u32 s58, s58, 40960
    buffer_store_dwordx4 v[200:203], v198, s[24:27], s58 offen sc1
    s_add_u32 s58, s58, s57
    v_mfma_f32_32x32x16_bf16 v[64:79], v[140:143], v[236:239], v[64:79]
    ds_read_b128 v[156:159], v179 offset:12288
    buffer_store_dwordx4 v[204:207], v198, s[24:27], s58 offen sc1
    v_mfma_f32_32x32x16_bf16 v[80:95], v[128:131], v[240:243], v[80:95]
    v_cvt_pk_bf16_f32 v208, v48, v49
    v_cvt_pk_bf16_f32 v209, v50, v51
    v_cvt_pk_bf16_f32 v210, v52, v53
    v_cvt_pk_bf16_f32 v211, v54, v55
    v_mfma_f32_32x32x16_bf16 v[80:95], v[132:135], v[244:247], v[80:95]
    v_cvt_pk_bf16_f32 v212, v56, v57
    v_cvt_pk_bf16_f32 v213, v58, v59
    v_cvt_pk_bf16_f32 v214, v60, v61
    v_cvt_pk_bf16_f32 v215, v62, v63
    v_mfma_f32_32x32x16_bf16 v[80:95], v[136:139], v[248:251], v[80:95]
    s_mul_i32 s58, s56, 1
    s_add_u32 s58, s58, 40960
    buffer_store_dwordx4 v[208:211], v198, s[24:27], s58 offen sc1
    s_add_u32 s58, s58, s57
    v_mfma_f32_32x32x16_bf16 v[80:95], v[140:143], v[252:255], v[80:95]
    buffer_store_dwordx4 v[212:215], v198, s[24:27], s58 offen sc1
    s_waitcnt lgkmcnt(0)
    s_barrier
    v_mfma_f32_32x32x16_bf16 v[96:111], v[144:147], v[224:227], v[96:111]
    v_cvt_pk_bf16_f32 v200, v64, v65
    v_cvt_pk_bf16_f32 v201, v66, v67
    v_cvt_pk_bf16_f32 v202, v68, v69
    v_cvt_pk_bf16_f32 v203, v70, v71
    v_mfma_f32_32x32x16_bf16 v[96:111], v[148:151], v[228:231], v[96:111]
    v_cvt_pk_bf16_f32 v204, v72, v73
    v_cvt_pk_bf16_f32 v205, v74, v75
    v_cvt_pk_bf16_f32 v206, v76, v77
    v_cvt_pk_bf16_f32 v207, v78, v79
    v_mfma_f32_32x32x16_bf16 v[96:111], v[152:155], v[232:235], v[96:111]
    s_mul_i32 s58, s56, 0
    s_add_u32 s58, s58, 81920
    buffer_store_dwordx4 v[200:203], v198, s[24:27], s58 offen sc1
    s_add_u32 s58, s58, s57
    v_mfma_f32_32x32x16_bf16 v[96:111], v[156:159], v[236:239], v[96:111]
    buffer_store_dwordx4 v[204:207], v198, s[24:27], s58 offen sc1
    v_mfma_f32_32x32x16_bf16 v[112:127], v[144:147], v[240:243], v[112:127]
    v_cvt_pk_bf16_f32 v208, v80, v81
    v_cvt_pk_bf16_f32 v209, v82, v83
    v_cvt_pk_bf16_f32 v210, v84, v85
    v_cvt_pk_bf16_f32 v211, v86, v87
    v_mfma_f32_32x32x16_bf16 v[112:127], v[148:151], v[244:247], v[112:127]
    v_cvt_pk_bf16_f32 v212, v88, v89
    v_cvt_pk_bf16_f32 v213, v90, v91
    v_cvt_pk_bf16_f32 v214, v92, v93
    v_cvt_pk_bf16_f32 v215, v94, v95
    v_mfma_f32_32x32x16_bf16 v[112:127], v[152:155], v[248:251], v[112:127]
    s_mul_i32 s58, s56, 1
    s_add_u32 s58, s58, 81920
    buffer_store_dwordx4 v[208:211], v198, s[24:27], s58 offen sc1
    s_add_u32 s58, s58, s57
    v_mfma_f32_32x32x16_bf16 v[112:127], v[156:159], v[252:255], v[112:127]
    buffer_store_dwordx4 v[212:215], v198, s[24:27], s58 offen sc1
    v_cvt_pk_bf16_f32 v200, v96, v97
    v_cvt_pk_bf16_f32 v201, v98, v99
    v_cvt_pk_bf16_f32 v202, v100, v101
    v_cvt_pk_bf16_f32 v203, v102, v103
    v_cvt_pk_bf16_f32 v204, v104, v105
    v_cvt_pk_bf16_f32 v205, v106, v107
    v_cvt_pk_bf16_f32 v206, v108, v109
    v_cvt_pk_bf16_f32 v207, v110, v111
    s_mul_i32 s58, s56, 0
    s_add_u32 s58, s58, 122880
    buffer_store_dwordx4 v[200:203], v198, s[24:27], s58 offen sc1
    s_add_u32 s58, s58, s57
    buffer_store_dwordx4 v[204:207], v198, s[24:27], s58 offen sc1
    v_cvt_pk_bf16_f32 v208, v112, v113
    v_cvt_pk_bf16_f32 v209, v114, v115
    v_cvt_pk_bf16_f32 v210, v116, v117
    v_cvt_pk_bf16_f32 v211, v118, v119
    v_cvt_pk_bf16_f32 v212, v120, v121
    v_cvt_pk_bf16_f32 v213, v122, v123
    v_cvt_pk_bf16_f32 v214, v124, v125
    v_cvt_pk_bf16_f32 v215, v126, v127
    s_mul_i32 s58, s56, 1
    s_add_u32 s58, s58, 122880
    buffer_store_dwordx4 v[208:211], v198, s[24:27], s58 offen sc1
    s_add_u32 s58, s58, s57
    buffer_store_dwordx4 v[212:215], v198, s[24:27], s58 offen sc1
    s_branch concat_heads__linear_attn_block__sliding_block__prompt_kernel_fin1
concat_heads__linear_attn_block__sliding_block__prompt_kernel_fin1:
    v_mov_b32 v195, 0x2681c
    v_mov_b32 v196, 1
    s_mov_b64 exec, 1
    ds_add_u32 v195, v196
    s_mov_b64 exec, -1
    s_mov_b32 s22, 0
concat_heads__linear_attn_block__sliding_block__prompt_kernel_non3:
    s_waitcnt vmcnt(0)
    v_readlane_b32 s16, v220, 0
    v_readlane_b32 s17, v221, 0
    s_add_u32 s22, s22, 1
    s_nop 2
    s_cmp_lg_u32 s16, 0
    s_cbranch_scc1 concat_heads__linear_attn_block__sliding_block__prompt_kernel_nond4
    s_cmp_ge_u32 s22, 0x100000
    s_cbranch_scc1 concat_heads__linear_attn_block__sliding_block__prompt_kernel_nond4
    s_sleep 4
    buffer_load_dwordx2 v[220:221], v222, s[12:15], 0 offen sc1
    s_branch concat_heads__linear_attn_block__sliding_block__prompt_kernel_non3
concat_heads__linear_attn_block__sliding_block__prompt_kernel_nond4:
    s_lshl_b32 s19, s44, 3
    s_add_u32 s19, s19, s45
    s_lshl_b32 s19, s19, 4
    s_add_u32 s19, s19, s46
    s_lshl_b32 s19, s19, 3
    s_add_u32 s19, s19, 23592960
    v_mov_b32 v222, 0x26800
    v_mov_b32 v220, 1
    s_mov_b64 exec, 1
    ds_add_rtn_u32 v220, v222, v220
    s_waitcnt lgkmcnt(0)
    s_mov_b64 exec, -1
    v_readfirstlane_b32 s22, v220
    s_nop 3
    s_cmp_lg_u32 s22, 3
    s_cbranch_scc1 concat_heads__linear_attn_block__sliding_block__prompt_kernel_arr5
    v_mbcnt_lo_u32_b32 v222, -1, 0
    v_mbcnt_hi_u32_b32 v222, -1, v222
    v_lshlrev_b32 v222, 11, v222
    v_mov_b32 v220, s16
    v_mov_b32 v221, s17
    s_mov_b32 exec_lo, 0xffff
    s_mov_b32 exec_hi, 0
    buffer_store_dwordx2 v[220:221], v222, s[8:11], s19 offen sc1
    s_mov_b64 exec, -1
concat_heads__linear_attn_block__sliding_block__prompt_kernel_arr5:
    s_branch concat_heads__linear_attn_block__sliding_block__prompt_kernel_p2setup
concat_heads__linear_attn_block__sliding_block__prompt_kernel_p2c:
    s_barrier
    v_mov_b32 v222, 0
    buffer_load_dwordx2 v[220:221], v222, s[12:15], 0 offen sc1
    s_mov_b32 s22, 0
concat_heads__linear_attn_block__sliding_block__prompt_kernel_non6:
    s_waitcnt vmcnt(0)
    v_readlane_b32 s16, v220, 0
    v_readlane_b32 s17, v221, 0
    s_add_u32 s22, s22, 1
    s_nop 2
    s_cmp_lg_u32 s16, 0
    s_cbranch_scc1 concat_heads__linear_attn_block__sliding_block__prompt_kernel_nond7
    s_cmp_ge_u32 s22, 0x100000
    s_cbranch_scc1 concat_heads__linear_attn_block__sliding_block__prompt_kernel_nond7
    s_sleep 4
    buffer_load_dwordx2 v[220:221], v222, s[12:15], 0 offen sc1
    s_branch concat_heads__linear_attn_block__sliding_block__prompt_kernel_non6
concat_heads__linear_attn_block__sliding_block__prompt_kernel_nond7:
    s_branch concat_heads__linear_attn_block__sliding_block__prompt_kernel_p2setup
concat_heads__linear_attn_block__sliding_block__prompt_kernel_p1h:
    s_cmp_lt_u32 s71, 30
    s_cbranch_scc1 concat_heads__linear_attn_block__sliding_block__prompt_kernel_p1h2
    s_barrier
    s_branch concat_heads__linear_attn_block__sliding_block__prompt_kernel_p2h
concat_heads__linear_attn_block__sliding_block__prompt_kernel_p1h2:
    v_mbcnt_lo_u32_b32 v2, -1, 0
    v_mbcnt_hi_u32_b32 v2, -1, v2
    v_lshrrev_b32 v3, 3, v2
    s_lshl_b32 s18, s49, 6
    v_add_u32 v3, s18, v3
    s_movk_i32 s19, 1280
    v_mul_lo_u32 v3, v3, s19
    v_lshrrev_b32 v4, 4, v2
    v_and_b32 v5, 7, v2
    v_xor_b32 v20, v5, v4
    v_lshl_add_u32 v20, v20, 4, v3
    v_add_u32 v4, 4, v4
    v_xor_b32 v21, v5, v4
    v_lshl_add_u32 v21, v21, 4, v3
    v_add_u32 v8, 0, v20
    v_add_u32 v9, 9216, v21
    v_add_u32 v10, 18432, v20
    v_add_u32 v11, 27648, v21
    v_add_u32 v12, 40960, v20
    v_add_u32 v13, 50176, v21
    v_add_u32 v14, 59392, v20
    v_add_u32 v15, 68608, v21
    v_lshrrev_b32 v4, 4, v2
    s_lshl_b32 s18, s49, 4
    v_add_u32 v3, s18, v4
    s_movk_i32 s19, 3840
    v_mul_lo_u32 v3, v3, s19
    v_lshlrev_b32 v4, 2, v4
    v_and_b32 v5, 15, v2
    v_xor_b32 v5, v5, v4
    v_lshl_add_u32 v3, v5, 4, v3
    v_add_u32 v16, 0, v3
    v_add_u32 v17, 14336, v3
    v_add_u32 v18, 28672, v3
    v_add_u32 v19, 43008, v3
    s_cmp_eq_u32 s44, 0
    s_cselect_b32 s36, s36, s40
    s_cselect_b32 s37, s37, s41
    s_cselect_b32 s38, s38, s42
    s_cselect_b32 s39, s39, s43
    s_mul_i32 s18, s45, 327680
    s_add_u32 s36, s36, s18
    s_addc_u32 s37, s37, 0
    s_lshl_b32 s18, s46, 8
    s_add_u32 s38, s38, s18
    s_addc_u32 s39, s39, 0
    s_sub_u32 s19, 2457600, s18
    s_mov_b32 s24, s36
    s_and_b32 s25, s37, 0xffff
    s_mov_b32 s26, 0x50000
    s_mov_b32 s27, 0x20000
    s_mov_b32 s28, s38
    s_and_b32 s29, s39, 0xffff
    s_mov_b32 s30, s19
    s_mov_b32 s31, 0x20000
    s_load_dwordx2 s[4:5], s[0:1], 16
    s_load_dwordx2 s[6:7], s[0:1], 40
    s_lshl_b32 s58, s71, 2
    s_add_u32 s58, s58, s49
    s_mul_i32 s58, s58, 6912
    v_lshlrev_b32 v6, 7, v2
    s_mov_b32 s52, 0
    s_mov_b32 s53, 0
    s_mov_b32 s56, 0
    s_mov_b32 s57, 0
concat_heads__linear_attn_block__sliding_block__prompt_kernel_hpro:
    s_lshl_b32 s18, s49, 13
    s_add_u32 s54, s56, s18
    s_lshl_b32 s18, s49, 12
    s_add_u32 s18, s18, s56
    s_add_u32 s55, s18, 32768
    s_mov_b32 m0, s54
    s_nop 0
    buffer_load_dwordx4 v8, s[24:27], s52 offen offset:0 lds
    buffer_load_dwordx4 v9, s[24:27], s52 offen offset:1024 lds
    buffer_load_dwordx4 v10, s[24:27], s52 offen offset:2048 lds
    buffer_load_dwordx4 v11, s[24:27], s52 offen offset:3072 lds
    s_add_u32 m0, s54, 4096
    s_nop 0
    buffer_load_dwordx4 v12, s[24:27], s52 offen offset:0 lds
    buffer_load_dwordx4 v13, s[24:27], s52 offen offset:1024 lds
    buffer_load_dwordx4 v14, s[24:27], s52 offen offset:2048 lds
    buffer_load_dwordx4 v15, s[24:27], s52 offen offset:3072 lds
    s_mov_b32 m0, s55
    s_nop 0
    buffer_load_dwordx4 v16, s[28:31], s53 offen offset:0 lds
    buffer_load_dwordx4 v17, s[28:31], s53 offen offset:1024 lds
    buffer_load_dwordx4 v18, s[28:31], s53 offen offset:2048 lds
    buffer_load_dwordx4 v19, s[28:31], s53 offen offset:3072 lds
    s_add_u32 s52, s52, 128
    s_add_u32 s53, s53, 245760
    s_add_u32 s56, s56, 49152
    s_cmp_ge_u32 s56, 147456
    s_cselect_b32 s56, 0, s56
    s_add_u32 s57, s57, 1
    s_cmp_eq_u32 s57, 2
    s_cbranch_scc0 concat_heads__linear_attn_block__sliding_block__prompt_kernel_hpro_n
    s_waitcnt vmcnt(12)
    s_barrier
concat_heads__linear_attn_block__sliding_block__prompt_kernel_hpro_n:
    s_cmp_lt_u32 s57, 3
    s_cbranch_scc1 concat_heads__linear_attn_block__sliding_block__prompt_kernel_hpro
    s_mov_b32 s57, 0
concat_heads__linear_attn_block__sliding_block__prompt_kernel_hloop:
    s_cmp_lt_u32 s57, 8
    s_cbranch_scc1 concat_heads__linear_attn_block__sliding_block__prompt_kernel_hw12
    s_waitcnt vmcnt(0)
    s_branch concat_heads__linear_attn_block__sliding_block__prompt_kernel_hw
concat_heads__linear_attn_block__sliding_block__prompt_kernel_hw12:
    s_waitcnt vmcnt(12)
concat_heads__linear_attn_block__sliding_block__prompt_kernel_hw:
    s_barrier
    s_cmp_lt_u32 s57, 7
    s_cbranch_scc0 concat_heads__linear_attn_block__sliding_block__prompt_kernel_hnodma
    s_lshl_b32 s18, s49, 13
    s_add_u32 s54, s56, s18
    s_lshl_b32 s18, s49, 12
    s_add_u32 s18, s18, s56
    s_add_u32 s55, s18, 32768
    s_mov_b32 m0, s54
    s_nop 0
    buffer_load_dwordx4 v8, s[24:27], s52 offen offset:0 lds
    buffer_load_dwordx4 v9, s[24:27], s52 offen offset:1024 lds
    buffer_load_dwordx4 v10, s[24:27], s52 offen offset:2048 lds
    buffer_load_dwordx4 v11, s[24:27], s52 offen offset:3072 lds
    s_add_u32 m0, s54, 4096
    s_nop 0
    buffer_load_dwordx4 v12, s[24:27], s52 offen offset:0 lds
    buffer_load_dwordx4 v13, s[24:27], s52 offen offset:1024 lds
    buffer_load_dwordx4 v14, s[24:27], s52 offen offset:2048 lds
    buffer_load_dwordx4 v15, s[24:27], s52 offen offset:3072 lds
    s_mov_b32 m0, s55
    s_nop 0
    buffer_load_dwordx4 v16, s[28:31], s53 offen offset:0 lds
    buffer_load_dwordx4 v17, s[28:31], s53 offen offset:1024 lds
    buffer_load_dwordx4 v18, s[28:31], s53 offen offset:2048 lds
    buffer_load_dwordx4 v19, s[28:31], s53 offen offset:3072 lds
    s_add_u32 s52, s52, 128
    s_add_u32 s53, s53, 245760
    s_add_u32 s56, s56, 49152
    s_cmp_ge_u32 s56, 147456
    s_cselect_b32 s56, 0, s56
    s_cmp_eq_u32 s57, 3
    s_cbranch_scc0 concat_heads__linear_attn_block__sliding_block__prompt_kernel_hnodma
    s_waitcnt lgkmcnt(0)
    s_cmp_lt_u32 s70, 4
    s_cselect_b32 s4, s4, s6
    s_cselect_b32 s5, s5, s7
    s_mov_b32 s60, s4
    s_and_b32 s61, s5, 0xffff
    s_mov_b32 s62, 0xc8000
    s_mov_b32 s63, 0x20000
    s_mov_b32 exec_lo, -1
    s_mov_b32 exec_hi, 0x3fffff
    buffer_load_dword v7, v6, s[60:63], s58 offen
    s_mov_b64 exec, -1
    s_cmp_eq_u32 s49, 0
    s_cbranch_scc0 concat_heads__linear_attn_block__sliding_block__prompt_kernel_hnodma
    s_lshl_b32 s18, s70, 2
    s_and_b32 s19, s71, 3
    s_add_u32 s18, s18, s19
    s_and_b32 s18, s18, 15
    s_lshl_b32 s18, s18, 11
    s_add_u32 s18, s18, 23592960
    s_lshr_b32 s19, s71, 2
    s_lshl_b32 s19, s19, 7
    s_add_u32 s18, s18, s19
    v_lshlrev_b32 v23, 3, v2
    v_add_u32 v22, s18, v23
    v_subrev_u32 v22, 256, v22
    s_add_u32 s18, s18, 896
    v_add_u32 v23, s18, v23
    v_cmp_gt_u32 vcc, 32, v2
    s_nop 1
    v_cndmask_b32 v23, v22, v23, vcc
    s_mov_b32 exec_lo, -1
    s_mov_b32 exec_hi, 0xffff
    buffer_load_dword v24, v23, s[8:11], 0 offen sc1
    s_mov_b64 exec, -1
concat_heads__linear_attn_block__sliding_block__prompt_kernel_hnodma:
    s_add_u32 s57, s57, 1
    s_cmp_lt_u32 s57, 10
    s_cbranch_scc1 concat_heads__linear_attn_block__sliding_block__prompt_kernel_hloop
concat_heads__linear_attn_block__sliding_block__prompt_kernel_p2h:
    v_mov_b32 v222, 0
    buffer_load_dwordx2 v[220:221], v222, s[12:15], 0 offen sc1
    s_mov_b32 s22, 0
concat_heads__linear_attn_block__sliding_block__prompt_kernel_non8:
    s_waitcnt vmcnt(0)
    v_readlane_b32 s16, v220, 0
    v_readlane_b32 s17, v221, 0
    s_add_u32 s22, s22, 1
    s_nop 2
    s_cmp_lg_u32 s16, 0
    s_cbranch_scc1 concat_heads__linear_attn_block__sliding_block__prompt_kernel_nond9
    s_cmp_ge_u32 s22, 0x100000
    s_cbranch_scc1 concat_heads__linear_attn_block__sliding_block__prompt_kernel_nond9
    s_sleep 4
    buffer_load_dwordx2 v[220:221], v222, s[12:15], 0 offen sc1
    s_branch concat_heads__linear_attn_block__sliding_block__prompt_kernel_non8
concat_heads__linear_attn_block__sliding_block__prompt_kernel_nond9:
concat_heads__linear_attn_block__sliding_block__prompt_kernel_p2setup:
    s_lshl_b32 s18, s70, 2
    s_and_b32 s44, s71, 3
    s_add_u32 s44, s44, s18
    s_lshr_b32 s45, s71, 2
    s_mul_i32 s18, s44, 5
    s_lshr_b32 s46, s18, 2
    s_and_b32 s47, s18, 3
    s_lshl_b32 s48, s45, 3
    s_add_u32 s48, s48, s3
    s_add_u32 s49, s48, 1
    s_min_u32 s49, s49, 9
    s_mov_b32 s50, 0x000fffff
    s_mov_b32 s51, 0x000fffff
    s_mov_b32 s52, -1
    s_mov_b32 s53, 0xff
    v_mbcnt_lo_u32_b32 v231, -1, 0
    v_mbcnt_hi_u32_b32 v231, -1, v231
    v_lshlrev_b32 v242, 3, v231
    v_lshlrev_b32 v228, 4, v231
    s_mov_b32 s67, 0xf149f2ca
    v_and_b32 v235, 31, v231
    v_lshrrev_b32 v224, 5, v231
    v_lshlrev_b32 v224, 2, v224
    v_sub_u32 v235, v235, v224
    v_mov_b32 v225, s67
    v_mov_b32 v226, 0
    v_cmp_le_i32 s[36:37], 0, v235
    v_cmp_le_i32 s[38:39], 1, v235
    v_cmp_le_i32 s[40:41], 2, v235
    v_cmp_le_i32 s[42:43], 3, v235
    s_nop 1
    v_cndmask_b32 v184, v225, v226, s[36:37]
    v_cndmask_b32 v200, v226, v225, s[36:37]
    v_cndmask_b32 v185, v225, v226, s[38:39]
    v_cndmask_b32 v201, v226, v225, s[38:39]
    v_cndmask_b32 v186, v225, v226, s[40:41]
    v_cndmask_b32 v202, v226, v225, s[40:41]
    v_cndmask_b32 v187, v225, v226, s[42:43]
    v_cndmask_b32 v203, v226, v225, s[42:43]
    v_cmp_le_i32 s[36:37], 8, v235
    v_cmp_le_i32 s[38:39], 9, v235
    v_cmp_le_i32 s[40:41], 10, v235
    v_cmp_le_i32 s[42:43], 11, v235
    s_nop 1
    v_cndmask_b32 v188, v225, v226, s[36:37]
    v_cndmask_b32 v204, v226, v225, s[36:37]
    v_cndmask_b32 v189, v225, v226, s[38:39]
    v_cndmask_b32 v205, v226, v225, s[38:39]
    v_cndmask_b32 v190, v225, v226, s[40:41]
    v_cndmask_b32 v206, v226, v225, s[40:41]
    v_cndmask_b32 v191, v225, v226, s[42:43]
    v_cndmask_b32 v207, v226, v225, s[42:43]
    v_cmp_le_i32 s[36:37], 16, v235
    v_cmp_le_i32 s[38:39], 17, v235
    v_cmp_le_i32 s[40:41], 18, v235
    v_cmp_le_i32 s[42:43], 19, v235
    s_nop 1
    v_cndmask_b32 v192, v225, v226, s[36:37]
    v_cndmask_b32 v208, v226, v225, s[36:37]
    v_cndmask_b32 v193, v225, v226, s[38:39]
    v_cndmask_b32 v209, v226, v225, s[38:39]
    v_cndmask_b32 v194, v225, v226, s[40:41]
    v_cndmask_b32 v210, v226, v225, s[40:41]
    v_cndmask_b32 v195, v225, v226, s[42:43]
    v_cndmask_b32 v211, v226, v225, s[42:43]
    v_cmp_le_i32 s[36:37], 24, v235
    v_cmp_le_i32 s[38:39], 25, v235
    v_cmp_le_i32 s[40:41], 26, v235
    v_cmp_le_i32 s[42:43], 27, v235
    s_nop 1
    v_cndmask_b32 v196, v225, v226, s[36:37]
    v_cndmask_b32 v212, v226, v225, s[36:37]
    v_cndmask_b32 v197, v225, v226, s[38:39]
    v_cndmask_b32 v213, v226, v225, s[38:39]
    v_cndmask_b32 v198, v225, v226, s[40:41]
    v_cndmask_b32 v214, v226, v225, s[40:41]
    v_cndmask_b32 v199, v225, v226, s[42:43]
    v_cndmask_b32 v215, v226, v225, s[42:43]
    s_sub_u32 s18, 0, s47
    s_cmp_le_u32 s18, 4
    s_cselect_b32 s54, -1, 0
    s_sub_u32 s18, 1, s47
    s_cmp_le_u32 s18, 4
    s_cselect_b32 s55, -1, 0
    s_sub_u32 s18, 2, s47
    s_cmp_le_u32 s18, 4
    s_cselect_b32 s56, -1, 0
    s_sub_u32 s18, 3, s47
    s_cmp_le_u32 s18, 4
    s_cselect_b32 s57, -1, 0
    s_sub_u32 s18, 4, s47
    s_cmp_le_u32 s18, 4
    s_cselect_b32 s58, -1, 0
    s_sub_u32 s18, 5, s47
    s_cmp_le_u32 s18, 4
    s_cselect_b32 s59, -1, 0
    s_sub_u32 s18, 6, s47
    s_cmp_le_u32 s18, 4
    s_cselect_b32 s60, -1, 0
    s_sub_u32 s18, 7, s47
    s_cmp_le_u32 s18, 4
    s_cselect_b32 s61, -1, 0
    s_lshl_b32 s18, s3, 11
    s_add_u32 s18, s18, 102400
    v_add_u32 v229, s18, v228
    v_lshrrev_b32 v220, 5, v231
    v_mul_u32_u24 v220, 20, v220
    v_and_b32 v235, 31, v231
    v_add_u32 v220, v220, v235
    v_lshlrev_b32 v220, 4, v220
    s_mul_i32 s18, s3, 1280
    s_add_u32 s18, s18, 135168
    v_add_u32 v230, s18, v220
    s_lshl_b32 s18, s48, 5
    s_add_u32 s18, s18, s44
    s_mul_i32 s62, s18, 1280
    v_mov_b32 v232, v228
    v_add_u32 v233, 1024, v242
    v_mov_b32 v224, 0x40000000
    v_cmp_gt_u32 vcc, 32, v231
    s_nop 1
    v_cndmask_b32 v233, v224, v233, vcc
    s_mul_i32 s20, s48, 40
    s_add_u32 s20, s20, s46
    s_lshl_b32 s20, s20, 10
    s_add_u32 s63, s20, 0
    s_cmp_eq_u32 s3, 4
    s_cbranch_scc1 concat_heads__linear_attn_block__sliding_block__prompt_kernel_aearly
    s_cmp_eq_u32 s3, 5
    s_cbranch_scc1 concat_heads__linear_attn_block__sliding_block__prompt_kernel_w5
    s_cmp_ge_u32 s3, 6
    s_cbranch_scc1 concat_heads__linear_attn_block__sliding_block__prompt_kernel_w67
    v_mov_b32 v220, 0x26804
    s_mov_b32 s22, 0
concat_heads__linear_attn_block__sliding_block__prompt_kernel_lw10:
    ds_read_b32 v221, v220
    s_waitcnt lgkmcnt(0)
    v_readfirstlane_b32 s18, v221
    s_add_u32 s22, s22, 1
    s_nop 2
    s_cmp_ge_u32 s18, 1
    s_cbranch_scc1 concat_heads__linear_attn_block__sliding_block__prompt_kernel_lwd11
    s_cmp_ge_u32 s22, 0x1000000
    s_cbranch_scc1 concat_heads__linear_attn_block__sliding_block__prompt_kernel_lwd11
    s_sleep 1
    s_branch concat_heads__linear_attn_block__sliding_block__prompt_kernel_lw10
concat_heads__linear_attn_block__sliding_block__prompt_kernel_lwd11:
    s_lshl_b32 s7, s3, 2
    s_cmp_eq_u32 s45, 0
    s_cselect_b32 s18, 8, 0
    s_cmp_lt_u32 s7, s18
    s_cbranch_scc1 concat_heads__linear_attn_block__sliding_block__prompt_kernel_nok
    s_lshl_b32 s4, s45, 3
    s_add_u32 s4, s4, s7
    s_sub_u32 s4, s4, 8
    s_mul_i32 s5, s4, 40
    s_add_u32 s5, s5, s46
    s_lshl_b32 s5, s5, 10
    s_add_u32 s5, s5, 10485760
    s_lshl_b32 s6, s7, 11
    s_add_u32 s6, s6, 102400
    s_add_u32 m0, s6, 0
    s_nop 0
    buffer_load_dwordx4 v228, s[8:11], s5 offen sc1 lds
    buffer_load_dwordx4 v228, s[8:11], s5 offen offset:1024 sc1 lds
    s_add_u32 s5, s5, 40960
    s_add_u32 m0, s6, 2048
    s_nop 0
    buffer_load_dwordx4 v228, s[8:11], s5 offen sc1 lds
    buffer_load_dwordx4 v228, s[8:11], s5 offen offset:1024 sc1 lds
    s_add_u32 s5, s5, 40960
    s_add_u32 m0, s6, 4096
    s_nop 0
    buffer_load_dwordx4 v228, s[8:11], s5 offen sc1 lds
    buffer_load_dwordx4 v228, s[8:11], s5 offen offset:1024 sc1 lds
    s_add_u32 s5, s5, 40960
    s_add_u32 m0, s6, 6144
    s_nop 0
    buffer_load_dwordx4 v228, s[8:11], s5 offen sc1 lds
    buffer_load_dwordx4 v228, s[8:11], s5 offen offset:1024 sc1 lds
concat_heads__linear_attn_block__sliding_block__prompt_kernel_nok:
    s_add_u32 s21, s63, 7864320
    buffer_load_dwordx4 v[160:163], v228, s[8:11], s21 offen sc1
    buffer_load_dwordx4 v[164:167], v228, s[8:11], s21 offen offset:1024 sc1
    s_waitcnt vmcnt(0)
    v_mov_b32 v220, 0x26820
    v_mov_b32 v221, 1
    s_mov_b64 exec, 1
    ds_add_u32 v220, v221
    s_mov_b64 exec, -1
    s_branch concat_heads__linear_attn_block__sliding_block__prompt_kernel_kwait
concat_heads__linear_attn_block__sliding_block__prompt_kernel_w67:
    s_lshr_b32 s64, s70, 2
    s_and_b32 s18, s70, 3
    s_lshl_b32 s18, s18, 2
    s_lshr_b32 s65, s71, 3
    s_add_u32 s65, s65, s18
    s_and_b32 s66, s71, 7
    s_load_dwordx2 s[4:5], s[0:1], 16
    s_load_dwordx2 s[6:7], s[0:1], 40
    s_movk_i32 s20, 6554
    s_movk_i32 s21, 1280
    v_add_u32 v220, 0, v231
    v_mul_lo_u32 v221, v220, s20
    v_lshrrev_b32 v221, 16, v221
    v_mul_u32_u24 v222, 10, v221
    v_sub_u32 v220, v220, v222
    v_lshlrev_b32 v220, 4, v220
    v_mad_u32_u24 v243, v221, s21, v220
    v_add_u32 v220, 64, v231
    v_mul_lo_u32 v221, v220, s20
    v_lshrrev_b32 v221, 16, v221
    v_mul_u32_u24 v222, 10, v221
    v_sub_u32 v220, v220, v222
    v_lshlrev_b32 v220, 4, v220
    v_mad_u32_u24 v244, v221, s21, v220
    v_subrev_u32 v244, 1024, v244
    v_add_u32 v220, 128, v231
    v_mul_lo_u32 v221, v220, s20
    v_lshrrev_b32 v221, 16, v221
    v_mul_u32_u24 v222, 10, v221
    v_sub_u32 v220, v220, v222
    v_lshlrev_b32 v220, 4, v220
    v_mad_u32_u24 v245, v221, s21, v220
    v_subrev_u32 v245, 2048, v245
    v_add_u32 v220, 192, v231
    v_mul_lo_u32 v221, v220, s20
    v_lshrrev_b32 v221, 16, v221
    v_mul_u32_u24 v222, 10, v221
    v_sub_u32 v220, v220, v222
    v_lshlrev_b32 v220, 4, v220
    v_mad_u32_u24 v246, v221, s21, v220
    v_subrev_u32 v246, 3072, v246
    v_add_u32 v220, 256, v231
    v_mul_lo_u32 v221, v220, s20
    v_lshrrev_b32 v221, 16, v221
    v_mul_u32_u24 v222, 10, v221
    v_sub_u32 v220, v220, v222
    v_lshlrev_b32 v220, 4, v220
    v_mad_u32_u24 v247, v221, s21, v220
    s_waitcnt lgkmcnt(0)
    s_cmp_eq_u32 s64, 0
    s_cselect_b32 s4, s4, s6
    s_cselect_b32 s5, s5, s7
    s_mul_i32 s18, s66, 160
    s_add_u32 s4, s4, s18
    s_addc_u32 s5, s5, 0
    s_sub_u32 s19, 819200, s18
    s_mov_b32 s24, s4
    s_and_b32 s25, s5, 0xffff
    s_mov_b32 s26, s19
    s_mov_b32 s27, 0x20000
    s_and_b32 s18, s3, 1
    s_mul_i32 s4, s18, 40960
    s_mul_i32 s5, s18, 5120
    s_cmp_ge_u32 s71, 30
    s_cbranch_scc1 concat_heads__linear_attn_block__sliding_block__prompt_kernel_wogo
    v_mov_b32 v220, 0x2681c
    s_mov_b32 s22, 0
concat_heads__linear_attn_block__sliding_block__prompt_kernel_lw12:
    ds_read_b32 v221, v220
    s_waitcnt lgkmcnt(0)
    v_readfirstlane_b32 s18, v221
    s_add_u32 s22, s22, 1
    s_nop 2
    s_cmp_ge_u32 s18, 4
    s_cbranch_scc1 concat_heads__linear_attn_block__sliding_block__prompt_kernel_lwd13
    s_cmp_ge_u32 s22, 0x1000000
    s_cbranch_scc1 concat_heads__linear_attn_block__sliding_block__prompt_kernel_lwd13
    s_sleep 1
    s_branch concat_heads__linear_attn_block__sliding_block__prompt_kernel_lw12
concat_heads__linear_attn_block__sliding_block__prompt_kernel_lwd13:
concat_heads__linear_attn_block__sliding_block__prompt_kernel_wogo:
    s_mov_b32 s6, 0
concat_heads__linear_attn_block__sliding_block__prompt_kernel_woloop:
    s_mov_b32 m0, s5
    s_nop 0
    buffer_load_dwordx4 v243, s[24:27], s4 offen lds
    buffer_load_dwordx4 v244, s[24:27], s4 offen offset:1024 lds
    buffer_load_dwordx4 v245, s[24:27], s4 offen offset:2048 lds
    buffer_load_dwordx4 v246, s[24:27], s4 offen offset:3072 lds
    s_add_u32 m0, s5, 4096
    s_nop 0
    buffer_load_dwordx4 v247, s[24:27], s4 offen lds
    s_add_u32 s4, s4, 81920
    s_add_u32 s5, s5, 10240
    s_add_u32 s6, s6, 1
    s_cmp_lt_u32 s6, 10
    s_cbranch_scc1 concat_heads__linear_attn_block__sliding_block__prompt_kernel_woloop
    v_mov_b32 v220, 0x26804
    s_mov_b32 s22, 0
concat_heads__linear_attn_block__sliding_block__prompt_kernel_lw14:
    ds_read_b32 v221, v220
    s_waitcnt lgkmcnt(0)
    v_readfirstlane_b32 s18, v221
    s_add_u32 s22, s22, 1
    s_nop 2
    s_cmp_ge_u32 s18, 1
    s_cbranch_scc1 concat_heads__linear_attn_block__sliding_block__prompt_kernel_lwd15
    s_cmp_ge_u32 s22, 0x1000000
    s_cbranch_scc1 concat_heads__linear_attn_block__sliding_block__prompt_kernel_lwd15
    s_sleep 1
    s_branch concat_heads__linear_attn_block__sliding_block__prompt_kernel_lw14
concat_heads__linear_attn_block__sliding_block__prompt_kernel_lwd15:
    s_waitcnt vmcnt(30)
    s_add_u32 s21, s63, 7864320
    buffer_load_dwordx4 v[160:163], v228, s[8:11], s21 offen sc1
    buffer_load_dwordx4 v[164:167], v228, s[8:11], s21 offen offset:1024 sc1
    v_cmp_le_u32 vcc, 20, v231
    v_mov_b32 v220, 0
    v_mov_b32 v221, 9920
    v_cndmask_b32 v220, v220, v221, vcc
    v_add_u32 v234, v220, v228
    s_and_b32 s7, s3, 1
    s_lshl_b32 s7, s7, 3
    s_or_b32 s18, s7, s45
    s_cmp_eq_u32 s18, 0
    s_cbranch_scc1 concat_heads__linear_attn_block__sliding_block__prompt_kernel_nov
    s_lshl_b32 s4, s45, 3
    s_add_u32 s4, s4, s7
    s_sub_u32 s4, s4, 8
    s_mul_i32 s5, s4, 40960
    s_mul_i32 s19, s44, 320
    s_add_u32 s5, s5, s19
    s_add_u32 s5, s5, 13107200
    s_mul_i32 s6, s7, 1280
    s_add_u32 s6, s6, 135168
    s_mov_b64 exec, s[52:53]
    s_add_u32 m0, s6, 0
    s_add_u32 s19, s5, 19840
    buffer_load_dwordx4 v234, s[8:11], s5 offen sc1 lds
    buffer_load_dwordx4 v234, s[8:11], s19 offen offset:640 sc1 lds
    s_add_u32 s5, s5, 40960
    s_add_u32 m0, s6, 1280
    s_add_u32 s19, s5, 19840
    buffer_load_dwordx4 v234, s[8:11], s5 offen sc1 lds
    buffer_load_dwordx4 v234, s[8:11], s19 offen offset:640 sc1 lds
    s_add_u32 s5, s5, 40960
    s_add_u32 m0, s6, 2560
    s_add_u32 s19, s5, 19840
    buffer_load_dwordx4 v234, s[8:11], s5 offen sc1 lds
    buffer_load_dwordx4 v234, s[8:11], s19 offen offset:640 sc1 lds
    s_add_u32 s5, s5, 40960
    s_add_u32 m0, s6, 3840
    s_add_u32 s19, s5, 19840
    buffer_load_dwordx4 v234, s[8:11], s5 offen sc1 lds
    buffer_load_dwordx4 v234, s[8:11], s19 offen offset:640 sc1 lds
    s_add_u32 s5, s5, 40960
    s_add_u32 m0, s6, 5120
    s_add_u32 s19, s5, 19840
    buffer_load_dwordx4 v234, s[8:11], s5 offen sc1 lds
    buffer_load_dwordx4 v234, s[8:11], s19 offen offset:640 sc1 lds
    s_add_u32 s5, s5, 40960
    s_add_u32 m0, s6, 6400
    s_add_u32 s19, s5, 19840
    buffer_load_dwordx4 v234, s[8:11], s5 offen sc1 lds
    buffer_load_dwordx4 v234, s[8:11], s19 offen offset:640 sc1 lds
    s_add_u32 s5, s5, 40960
    s_add_u32 m0, s6, 7680
    s_add_u32 s19, s5, 19840
    buffer_load_dwordx4 v234, s[8:11], s5 offen sc1 lds
    buffer_load_dwordx4 v234, s[8:11], s19 offen offset:640 sc1 lds
    s_add_u32 s5, s5, 40960
    s_add_u32 m0, s6, 8960
    s_add_u32 s19, s5, 19840
    buffer_load_dwordx4 v234, s[8:11], s5 offen sc1 lds
    buffer_load_dwordx4 v234, s[8:11], s19 offen offset:640 sc1 lds
    s_mov_b64 exec, -1
    s_waitcnt vmcnt(16)
    s_branch concat_heads__linear_attn_block__sliding_block__prompt_kernel_kwait
concat_heads__linear_attn_block__sliding_block__prompt_kernel_nov:
    s_waitcnt vmcnt(0)
    s_branch concat_heads__linear_attn_block__sliding_block__prompt_kernel_kwait
concat_heads__linear_attn_block__sliding_block__prompt_kernel_w5:
    s_cmp_ge_u32 s71, 30
    s_cbranch_scc1 concat_heads__linear_attn_block__sliding_block__prompt_kernel_otw16
    v_mov_b32 v220, 0x26800
    s_mov_b32 s22, 0
concat_heads__linear_attn_block__sliding_block__prompt_kernel_lw17:
    ds_read_b32 v221, v220
    s_waitcnt lgkmcnt(0)
    v_readfirstlane_b32 s18, v221
    s_add_u32 s22, s22, 1
    s_nop 2
    s_cmp_ge_u32 s18, 4
    s_cbranch_scc1 concat_heads__linear_attn_block__sliding_block__prompt_kernel_lwd18
    s_cmp_ge_u32 s22, 0x1000000
    s_cbranch_scc1 concat_heads__linear_attn_block__sliding_block__prompt_kernel_lwd18
    s_sleep 1
    s_branch concat_heads__linear_attn_block__sliding_block__prompt_kernel_lw17
concat_heads__linear_attn_block__sliding_block__prompt_kernel_lwd18:
concat_heads__linear_attn_block__sliding_block__prompt_kernel_otw16:
    s_add_u32 s18, s45, 7
    s_lshl_b32 s18, s18, 7
    s_and_b32 s19, s44, 15
    s_lshl_b32 s19, s19, 11
    s_add_u32 s18, s18, s19
    s_add_u32 s23, s18, 23592960
    s_lshr_b32 s19, s46, 3
    s_lshl_b32 s19, 1, s19
    s_add_u32 s20, s46, 1
    s_lshr_b32 s20, s20, 3
    s_lshl_b32 s20, 1, s20
    s_or_b32 s19, s19, s20
    s_mul_i32 s21, s44, 20
    s_lshr_b32 s20, s21, 7
    s_lshl_b32 s20, 1, s20
    s_add_u32 s21, s21, 19
    s_lshr_b32 s21, s21, 7
    s_lshl_b32 s21, 1, s21
    s_or_b32 s20, s20, s21
    s_lshl_b32 s21, s19, 5
    s_lshl_b32 s20, s20, 10
    s_or_b32 s21, s21, s20
    s_or_b32 s19, s19, s21
    s_lshl_b32 s19, s19, 16
    s_cmp_eq_u32 s45, 0
    s_cselect_b32 s21, 0, s21
    s_or_b32 s19, s19, s21
    s_mov_b32 s32, s19
    s_mov_b32 s33, 0x0
    s_mov_b32 exec_lo, 0xffffffff
    s_mov_b32 exec_hi, 0
    buffer_load_dwordx2 v[220:221], v242, s[8:11], s23 offen sc1
    s_mov_b64 exec, -1
    s_mov_b32 s22, 0
concat_heads__linear_attn_block__sliding_block__prompt_kernel_poll19:
    s_waitcnt vmcnt(0)
    v_cmp_eq_u32 vcc, s16, v220
    v_cmp_eq_u32 s[34:35], s17, v221
    s_add_u32 s22, s22, 1
    s_nop 3
    s_and_b64 s[34:35], s[34:35], vcc
    s_and_b64 s[34:35], s[34:35], s[32:33]
    s_cmp_eq_u64 s[34:35], s[32:33]
    s_cbranch_scc1 concat_heads__linear_attn_block__sliding_block__prompt_kernel_polld20
    s_cmp_ge_u32 s22, 0x100000
    s_cbranch_scc1 concat_heads__linear_attn_block__sliding_block__prompt_kernel_polld20
    s_sleep 3
    s_mov_b32 exec_lo, 0xffffffff
    s_mov_b32 exec_hi, 0
    buffer_load_dwordx2 v[220:221], v242, s[8:11], s23 offen sc1
    s_mov_b64 exec, -1
    s_branch concat_heads__linear_attn_block__sliding_block__prompt_kernel_poll19
concat_heads__linear_attn_block__sliding_block__prompt_kernel_polld20:
    v_mov_b32 v220, 0x26804
    v_mov_b32 v221, 1
    ds_write_b32 v220, v221
    s_add_u32 s21, s63, 7864320
    buffer_load_dwordx4 v[160:163], v228, s[8:11], s21 offen sc1
    buffer_load_dwordx4 v[164:167], v228, s[8:11], s21 offen offset:1024 sc1
    s_waitcnt vmcnt(0)
    s_branch concat_heads__linear_attn_block__sliding_block__prompt_kernel_kwait
concat_heads__linear_attn_block__sliding_block__prompt_kernel_aearly:
    v_lshrrev_b32 v220, 5, v231
    v_mul_u32_u24 v220, 10240, v220
    v_and_b32 v235, 31, v231
    v_lshl_add_u32 v234, v235, 4, v220
    v_mov_b32 v222, 0x3f803f80
    v_mov_b32 v64, v222
    v_mov_b32 v65, v222
    v_mov_b32 v66, v222
    v_mov_b32 v67, v222
    v_mov_b32 v68, v222
    v_mov_b32 v69, v222
    v_mov_b32 v70, v222
    v_mov_b32 v71, v222
    v_mov_b32 v72, v222
    v_mov_b32 v73, v222
    v_mov_b32 v74, v222
    v_mov_b32 v75, v222
    v_mov_b32 v76, v222
    v_mov_b32 v77, v222
    v_mov_b32 v78, v222
    v_mov_b32 v79, v222
    v_mov_b32 v80, v222
    v_mov_b32 v81, v222
    v_mov_b32 v82, v222
    v_mov_b32 v83, v222
    v_mov_b32 v84, v222
    v_mov_b32 v85, v222
    v_mov_b32 v86, v222
    v_mov_b32 v87, v222
    v_mov_b32 v88, v222
    v_mov_b32 v89, v222
    v_mov_b32 v90, v222
    v_mov_b32 v91, v222
    v_mov_b32 v92, v222
    v_mov_b32 v93, v222
    v_mov_b32 v94, v222
    v_mov_b32 v95, v222
    v_mov_b32 v96, v222
    v_mov_b32 v97, v222
    v_mov_b32 v98, v222
    v_mov_b32 v99, v222
    v_mov_b32 v100, v222
    v_mov_b32 v101, v222
    v_mov_b32 v102, v222
    v_mov_b32 v103, v222
    v_mov_b32 v104, v222
    v_mov_b32 v105, v222
    v_mov_b32 v106, v222
    v_mov_b32 v107, v222
    v_mov_b32 v108, v222
    v_mov_b32 v109, v222
    v_mov_b32 v110, v222
    v_mov_b32 v111, v222
    v_mov_b32 v112, v222
    v_mov_b32 v113, v222
    v_mov_b32 v114, v222
    v_mov_b32 v115, v222
    v_mov_b32 v116, v222
    v_mov_b32 v117, v222
    v_mov_b32 v118, v222
    v_mov_b32 v119, v222
    v_mov_b32 v120, v222
    v_mov_b32 v121, v222
    v_mov_b32 v122, v222
    v_mov_b32 v123, v222
    v_mov_b32 v124, v222
    v_mov_b32 v125, v222
    v_mov_b32 v126, v222
    v_mov_b32 v127, v222
    s_cmp_ge_u32 s71, 30
    s_cbranch_scc1 concat_heads__linear_attn_block__sliding_block__prompt_kernel_otw21
    v_mov_b32 v220, 0x26800
    s_mov_b32 s22, 0
concat_heads__linear_attn_block__sliding_block__prompt_kernel_lw22:
    ds_read_b32 v221, v220
    s_waitcnt lgkmcnt(0)
    v_readfirstlane_b32 s18, v221
    s_add_u32 s22, s22, 1
    s_nop 2
    s_cmp_ge_u32 s18, 4
    s_cbranch_scc1 concat_heads__linear_attn_block__sliding_block__prompt_kernel_lwd23
    s_cmp_ge_u32 s22, 0x1000000
    s_cbranch_scc1 concat_heads__linear_attn_block__sliding_block__prompt_kernel_lwd23
    s_sleep 1
    s_branch concat_heads__linear_attn_block__sliding_block__prompt_kernel_lw22
concat_heads__linear_attn_block__sliding_block__prompt_kernel_lwd23:
concat_heads__linear_attn_block__sliding_block__prompt_kernel_otw21:
    s_lshl_b32 s18, s45, 7
    s_and_b32 s19, s44, 15
    s_lshl_b32 s19, s19, 11
    s_add_u32 s18, s18, s19
    s_add_u32 s23, s18, 23592960
    s_lshr_b32 s19, s46, 3
    s_lshl_b32 s19, 1, s19
    s_add_u32 s20, s46, 1
    s_lshr_b32 s20, s20, 3
    s_lshl_b32 s20, 1, s20
    s_or_b32 s19, s19, s20
    s_mul_i32 s21, s44, 20
    s_lshr_b32 s20, s21, 7
    s_lshl_b32 s20, 1, s20
    s_add_u32 s21, s21, 19
    s_lshr_b32 s21, s21, 7
    s_lshl_b32 s21, 1, s21
    s_or_b32 s20, s20, s21
    s_lshl_b32 s21, s20, 5
    s_lshl_b32 s20, s20, 10
    s_or_b32 s19, s19, s21
    s_or_b32 s19, s19, s20
    s_mov_b32 s32, s19
    s_mov_b32 s33, 0x0
    s_mov_b32 exec_lo, 0x7fff
    s_mov_b32 exec_hi, 0
    buffer_load_dwordx2 v[220:221], v242, s[8:11], s23 offen sc1
    s_mov_b64 exec, -1
    s_mov_b32 s22, 0
concat_heads__linear_attn_block__sliding_block__prompt_kernel_poll24:
    s_waitcnt vmcnt(0)
    v_cmp_eq_u32 vcc, s16, v220
    v_cmp_eq_u32 s[34:35], s17, v221
    s_add_u32 s22, s22, 1
    s_nop 3
    s_and_b64 s[34:35], s[34:35], vcc
    s_and_b64 s[34:35], s[34:35], s[32:33]
    s_cmp_eq_u64 s[34:35], s[32:33]
    s_cbranch_scc1 concat_heads__linear_attn_block__sliding_block__prompt_kernel_polld25
    s_cmp_ge_u32 s22, 0x100000
    s_cbranch_scc1 concat_heads__linear_attn_block__sliding_block__prompt_kernel_polld25
    s_sleep 3
    s_mov_b32 exec_lo, 0x7fff
    s_mov_b32 exec_hi, 0
    buffer_load_dwordx2 v[220:221], v242, s[8:11], s23 offen sc1
    s_mov_b64 exec, -1
    s_branch concat_heads__linear_attn_block__sliding_block__prompt_kernel_poll24
concat_heads__linear_attn_block__sliding_block__prompt_kernel_polld25:
    v_mov_b32 v220, 0x26808
    v_mov_b32 v221, 1
    ds_write_b32 v220, v221
    s_lshl_b32 s18, s45, 3
    s_mul_i32 s18, s18, 40960
    s_mul_i32 s19, s44, 320
    s_add_u32 s18, s18, s19
    s_add_u32 s19, s18, 2621440
    s_add_u32 s20, s18, 5242880
    s_mov_b64 exec, s[50:51]
    buffer_load_dwordx4 v[0:3], v234, s[8:11], s19 offen sc1
    buffer_load_dwordx4 v[64:67], v234, s[8:11], s20 offen sc1
    s_add_u32 s19, s19, 20480
    s_add_u32 s20, s20, 20480
    buffer_load_dwordx4 v[4:7], v234, s[8:11], s19 offen sc1
    buffer_load_dwordx4 v[68:71], v234, s[8:11], s20 offen sc1
    s_add_u32 s19, s19, 20480
    s_add_u32 s20, s20, 20480
    buffer_load_dwordx4 v[8:11], v234, s[8:11], s19 offen sc1
    buffer_load_dwordx4 v[72:75], v234, s[8:11], s20 offen sc1
    s_add_u32 s19, s19, 20480
    s_add_u32 s20, s20, 20480
    buffer_load_dwordx4 v[12:15], v234, s[8:11], s19 offen sc1
    buffer_load_dwordx4 v[76:79], v234, s[8:11], s20 offen sc1
    s_add_u32 s19, s19, 20480
    s_add_u32 s20, s20, 20480
    buffer_load_dwordx4 v[16:19], v234, s[8:11], s19 offen sc1
    buffer_load_dwordx4 v[80:83], v234, s[8:11], s20 offen sc1
    s_add_u32 s19, s19, 20480
    s_add_u32 s20, s20, 20480
    buffer_load_dwordx4 v[20:23], v234, s[8:11], s19 offen sc1
    buffer_load_dwordx4 v[84:87], v234, s[8:11], s20 offen sc1
    s_add_u32 s19, s19, 20480
    s_add_u32 s20, s20, 20480
    buffer_load_dwordx4 v[24:27], v234, s[8:11], s19 offen sc1
    buffer_load_dwordx4 v[88:91], v234, s[8:11], s20 offen sc1
    s_add_u32 s19, s19, 20480
    s_add_u32 s20, s20, 20480
    buffer_load_dwordx4 v[28:31], v234, s[8:11], s19 offen sc1
    buffer_load_dwordx4 v[92:95], v234, s[8:11], s20 offen sc1
    s_add_u32 s19, s19, 20480
    s_add_u32 s20, s20, 20480
    buffer_load_dwordx4 v[32:35], v234, s[8:11], s19 offen sc1
    buffer_load_dwordx4 v[96:99], v234, s[8:11], s20 offen sc1
    s_add_u32 s19, s19, 20480
    s_add_u32 s20, s20, 20480
    buffer_load_dwordx4 v[36:39], v234, s[8:11], s19 offen sc1
    buffer_load_dwordx4 v[100:103], v234, s[8:11], s20 offen sc1
    s_add_u32 s19, s19, 20480
    s_add_u32 s20, s20, 20480
    buffer_load_dwordx4 v[40:43], v234, s[8:11], s19 offen sc1
    buffer_load_dwordx4 v[104:107], v234, s[8:11], s20 offen sc1
    s_add_u32 s19, s19, 20480
    s_add_u32 s20, s20, 20480
    buffer_load_dwordx4 v[44:47], v234, s[8:11], s19 offen sc1
    buffer_load_dwordx4 v[108:111], v234, s[8:11], s20 offen sc1
    s_add_u32 s19, s19, 20480
    s_add_u32 s20, s20, 20480
    buffer_load_dwordx4 v[48:51], v234, s[8:11], s19 offen sc1
    buffer_load_dwordx4 v[112:115], v234, s[8:11], s20 offen sc1
    s_add_u32 s19, s19, 20480
    s_add_u32 s20, s20, 20480
    buffer_load_dwordx4 v[52:55], v234, s[8:11], s19 offen sc1
    buffer_load_dwordx4 v[116:119], v234, s[8:11], s20 offen sc1
    s_add_u32 s19, s19, 20480
    s_add_u32 s20, s20, 20480
    buffer_load_dwordx4 v[56:59], v234, s[8:11], s19 offen sc1
    buffer_load_dwordx4 v[120:123], v234, s[8:11], s20 offen sc1
    s_add_u32 s19, s19, 20480
    s_add_u32 s20, s20, 20480
    buffer_load_dwordx4 v[60:63], v234, s[8:11], s19 offen sc1
    buffer_load_dwordx4 v[124:127], v234, s[8:11], s20 offen sc1
    s_add_u32 s19, s19, 20480
    s_add_u32 s20, s20, 20480
    s_mov_b64 exec, -1
    v_mov_b32 v220, 0x26804
    s_mov_b32 s22, 0
concat_heads__linear_attn_block__sliding_block__prompt_kernel_lw26:
    ds_read_b32 v221, v220
    s_waitcnt lgkmcnt(0)
    v_readfirstlane_b32 s18, v221
    s_add_u32 s22, s22, 1
    s_nop 2
    s_cmp_ge_u32 s18, 1
    s_cbranch_scc1 concat_heads__linear_attn_block__sliding_block__prompt_kernel_lwd27
    s_cmp_ge_u32 s22, 0x1000000
    s_cbranch_scc1 concat_heads__linear_attn_block__sliding_block__prompt_kernel_lwd27
    s_sleep 1
    s_branch concat_heads__linear_attn_block__sliding_block__prompt_kernel_lw26
concat_heads__linear_attn_block__sliding_block__prompt_kernel_lwd27:
    s_add_u32 s21, s63, 7864320
    buffer_load_dwordx4 v[160:163], v228, s[8:11], s21 offen sc1
    buffer_load_dwordx4 v[164:167], v228, s[8:11], s21 offen offset:1024 sc1
    s_waitcnt vmcnt(32)
    v_mfma_f32_32x32x16_bf16 v[144:159], v[0:3], v[64:67], 0
    s_waitcnt vmcnt(30)
    v_mfma_f32_32x32x16_bf16 v[144:159], v[4:7], v[68:71], v[144:159]
    s_waitcnt vmcnt(28)
    v_mfma_f32_32x32x16_bf16 v[144:159], v[8:11], v[72:75], v[144:159]
    s_waitcnt vmcnt(26)
    v_mfma_f32_32x32x16_bf16 v[144:159], v[12:15], v[76:79], v[144:159]
    s_waitcnt vmcnt(24)
    v_mfma_f32_32x32x16_bf16 v[144:159], v[16:19], v[80:83], v[144:159]
    s_waitcnt vmcnt(22)
    v_mfma_f32_32x32x16_bf16 v[144:159], v[20:23], v[84:87], v[144:159]
    s_waitcnt vmcnt(20)
    v_mfma_f32_32x32x16_bf16 v[144:159], v[24:27], v[88:91], v[144:159]
    s_waitcnt vmcnt(18)
    v_mfma_f32_32x32x16_bf16 v[144:159], v[28:31], v[92:95], v[144:159]
    s_waitcnt vmcnt(16)
    v_mfma_f32_32x32x16_bf16 v[144:159], v[32:35], v[96:99], v[144:159]
    s_waitcnt vmcnt(14)
    v_mfma_f32_32x32x16_bf16 v[144:159], v[36:39], v[100:103], v[144:159]
    s_waitcnt vmcnt(12)
    v_mfma_f32_32x32x16_bf16 v[144:159], v[40:43], v[104:107], v[144:159]
    s_waitcnt vmcnt(10)
    v_mfma_f32_32x32x16_bf16 v[144:159], v[44:47], v[108:111], v[144:159]
    s_waitcnt vmcnt(8)
    v_mfma_f32_32x32x16_bf16 v[144:159], v[48:51], v[112:115], v[144:159]
    s_waitcnt vmcnt(6)
    v_mfma_f32_32x32x16_bf16 v[144:159], v[52:55], v[116:119], v[144:159]
    s_waitcnt vmcnt(4)
    v_mfma_f32_32x32x16_bf16 v[144:159], v[56:59], v[120:123], v[144:159]
    s_waitcnt vmcnt(2)
    v_mfma_f32_32x32x16_bf16 v[144:159], v[60:63], v[124:127], v[144:159]
    s_lshl_b32 s18, s44, 3
    s_add_u32 s18, s18, s45
    s_mul_i32 s18, s18, 3072
    s_add_u32 s18, s18, 20971520
    s_nop 7
    s_nop 1
    buffer_store_dwordx4 v[144:147], v228, s[8:11], s18 offen offset:0 sc1
    buffer_store_dwordx4 v[148:151], v228, s[8:11], s18 offen offset:1024 sc1
    buffer_store_dwordx4 v[152:155], v228, s[8:11], s18 offen offset:2048 sc1
    s_waitcnt vmcnt(3)
concat_heads__linear_attn_block__sliding_block__prompt_kernel_kwait:
    v_mov_b32 v220, 0x26820
    s_mov_b32 s22, 0
concat_heads__linear_attn_block__sliding_block__prompt_kernel_lw28:
    ds_read_b32 v221, v220
    s_waitcnt lgkmcnt(0)
    v_readfirstlane_b32 s18, v221
    s_add_u32 s22, s22, 1
    s_nop 2
    s_cmp_ge_u32 s18, 4
    s_cbranch_scc1 concat_heads__linear_attn_block__sliding_block__prompt_kernel_lwd29
    s_cmp_ge_u32 s22, 0x1000000
    s_cbranch_scc1 concat_heads__linear_attn_block__sliding_block__prompt_kernel_lwd29
    s_sleep 1
    s_branch concat_heads__linear_attn_block__sliding_block__prompt_kernel_lw28
concat_heads__linear_attn_block__sliding_block__prompt_kernel_lwd29:
    ds_read_b128 v[168:171], v229 offset:16384
    ds_read_b128 v[172:175], v229 offset:17408
    v_cndmask_b32 v160, 0, v160, s[54:55]
    v_cndmask_b32 v161, 0, v161, s[54:55]
    v_cndmask_b32 v162, 0, v162, s[56:57]
    v_cndmask_b32 v163, 0, v163, s[56:57]
    v_cndmask_b32 v164, 0, v164, s[58:59]
    v_cndmask_b32 v165, 0, v165, s[58:59]
    v_cndmask_b32 v166, 0, v166, s[60:61]
    v_cndmask_b32 v167, 0, v167, s[60:61]
    s_waitcnt lgkmcnt(0)
    ds_read_b128 v[176:179], v229 offset:14336
    ds_read_b128 v[180:183], v229 offset:15360
    s_nop 1
    v_mfma_f32_32x32x16_bf16 v[0:15], v[168:171], v[160:163], v[184:199]
    v_mfma_f32_32x32x16_bf16 v[0:15], v[172:175], v[164:167], v[0:15]
    s_waitcnt lgkmcnt(0)
    ds_read_b128 v[168:171], v229 offset:12288
    ds_read_b128 v[172:175], v229 offset:13312
    s_cmp_le_u32 s49, 1
    s_cbranch_scc1 concat_heads__linear_attn_block__sliding_block__prompt_kernel_p1skip1
    v_mfma_f32_32x32x16_bf16 v[16:31], v[176:179], v[160:163], 0
    v_mfma_f32_32x32x16_bf16 v[16:31], v[180:183], v[164:167], v[16:31]
concat_heads__linear_attn_block__sliding_block__prompt_kernel_p1skip1:
    s_nop 7
    v_max3_f32 v216, v0, v1, v2
    v_max3_f32 v216, v216, v3, v4
    v_max3_f32 v216, v216, v5, v6
    v_max3_f32 v216, v216, v7, v8
    v_max3_f32 v216, v216, v9, v10
    v_max3_f32 v216, v216, v11, v12
    v_max3_f32 v216, v216, v13, v14
    v_max_f32 v216, v216, v15
    s_cbranch_scc1 concat_heads__linear_attn_block__sliding_block__prompt_kernel_p1end
    s_waitcnt lgkmcnt(0)
    ds_read_b128 v[176:179], v229 offset:10240
    ds_read_b128 v[180:183], v229 offset:11264
    s_cmp_le_u32 s49, 2
    s_cbranch_scc1 concat_heads__linear_attn_block__sliding_block__prompt_kernel_p1skip2
    v_mfma_f32_32x32x16_bf16 v[32:47], v[168:171], v[160:163], 0
    v_mfma_f32_32x32x16_bf16 v[32:47], v[172:175], v[164:167], v[32:47]
concat_heads__linear_attn_block__sliding_block__prompt_kernel_p1skip2:
    v_max3_f32 v216, v216, v16, v17
    v_max3_f32 v216, v216, v18, v19
    v_max3_f32 v216, v216, v20, v21
    v_max3_f32 v216, v216, v22, v23
    v_max3_f32 v216, v216, v24, v25
    v_max3_f32 v216, v216, v26, v27
    v_max3_f32 v216, v216, v28, v29
    v_max3_f32 v216, v216, v30, v31
    s_cbranch_scc1 concat_heads__linear_attn_block__sliding_block__prompt_kernel_p1end
    s_waitcnt lgkmcnt(0)
    ds_read_b128 v[168:171], v229 offset:8192
    ds_read_b128 v[172:175], v229 offset:9216
    s_cmp_le_u32 s49, 3
    s_cbranch_scc1 concat_heads__linear_attn_block__sliding_block__prompt_kernel_p1skip3
    v_mfma_f32_32x32x16_bf16 v[48:63], v[176:179], v[160:163], 0
    v_mfma_f32_32x32x16_bf16 v[48:63], v[180:183], v[164:167], v[48:63]
concat_heads__linear_attn_block__sliding_block__prompt_kernel_p1skip3:
    v_max3_f32 v216, v216, v32, v33
    v_max3_f32 v216, v216, v34, v35
    v_max3_f32 v216, v216, v36, v37
    v_max3_f32 v216, v216, v38, v39
    v_max3_f32 v216, v216, v40, v41
    v_max3_f32 v216, v216, v42, v43
    v_max3_f32 v216, v216, v44, v45
    v_max3_f32 v216, v216, v46, v47
    s_cbranch_scc1 concat_heads__linear_attn_block__sliding_block__prompt_kernel_p1end
    s_waitcnt lgkmcnt(0)
    ds_read_b128 v[176:179], v229 offset:6144
    ds_read_b128 v[180:183], v229 offset:7168
    s_cmp_le_u32 s49, 4
    s_cbranch_scc1 concat_heads__linear_attn_block__sliding_block__prompt_kernel_p1skip4
    v_mfma_f32_32x32x16_bf16 v[64:79], v[168:171], v[160:163], 0
    v_mfma_f32_32x32x16_bf16 v[64:79], v[172:175], v[164:167], v[64:79]
concat_heads__linear_attn_block__sliding_block__prompt_kernel_p1skip4:
    v_max3_f32 v216, v216, v48, v49
    v_max3_f32 v216, v216, v50, v51
    v_max3_f32 v216, v216, v52, v53
    v_max3_f32 v216, v216, v54, v55
    v_max3_f32 v216, v216, v56, v57
    v_max3_f32 v216, v216, v58, v59
    v_max3_f32 v216, v216, v60, v61
    v_max3_f32 v216, v216, v62, v63
    s_cbranch_scc1 concat_heads__linear_attn_block__sliding_block__prompt_kernel_p1end
    s_waitcnt lgkmcnt(0)
    ds_read_b128 v[168:171], v229 offset:4096
    ds_read_b128 v[172:175], v229 offset:5120
    s_cmp_le_u32 s49, 5
    s_cbranch_scc1 concat_heads__linear_attn_block__sliding_block__prompt_kernel_p1skip5
    v_mfma_f32_32x32x16_bf16 v[80:95], v[176:179], v[160:163], 0
    v_mfma_f32_32x32x16_bf16 v[80:95], v[180:183], v[164:167], v[80:95]
concat_heads__linear_attn_block__sliding_block__prompt_kernel_p1skip5:
    v_max3_f32 v216, v216, v64, v65
    v_max3_f32 v216, v216, v66, v67
    v_max3_f32 v216, v216, v68, v69
    v_max3_f32 v216, v216, v70, v71
    v_max3_f32 v216, v216, v72, v73
    v_max3_f32 v216, v216, v74, v75
    v_max3_f32 v216, v216, v76, v77
    v_max3_f32 v216, v216, v78, v79
    s_cbranch_scc1 concat_heads__linear_attn_block__sliding_block__prompt_kernel_p1end
    s_waitcnt lgkmcnt(0)
    ds_read_b128 v[176:179], v229 offset:2048
    ds_read_b128 v[180:183], v229 offset:3072
    s_cmp_le_u32 s49, 6
    s_cbranch_scc1 concat_heads__linear_attn_block__sliding_block__prompt_kernel_p1skip6
    v_mfma_f32_32x32x16_bf16 v[96:111], v[168:171], v[160:163], 0
    v_mfma_f32_32x32x16_bf16 v[96:111], v[172:175], v[164:167], v[96:111]
concat_heads__linear_attn_block__sliding_block__prompt_kernel_p1skip6:
    v_max3_f32 v216, v216, v80, v81
    v_max3_f32 v216, v216, v82, v83
    v_max3_f32 v216, v216, v84, v85
    v_max3_f32 v216, v216, v86, v87
    v_max3_f32 v216, v216, v88, v89
    v_max3_f32 v216, v216, v90, v91
    v_max3_f32 v216, v216, v92, v93
    v_max3_f32 v216, v216, v94, v95
    s_cbranch_scc1 concat_heads__linear_attn_block__sliding_block__prompt_kernel_p1end
    s_waitcnt lgkmcnt(0)
    ds_read_b128 v[168:171], v229 offset:0
    ds_read_b128 v[172:175], v229 offset:1024
    s_cmp_le_u32 s49, 7
    s_cbranch_scc1 concat_heads__linear_attn_block__sliding_block__prompt_kernel_p1skip7
    v_mfma_f32_32x32x16_bf16 v[112:127], v[176:179], v[160:163], 0
    v_mfma_f32_32x32x16_bf16 v[112:127], v[180:183], v[164:167], v[112:127]
concat_heads__linear_attn_block__sliding_block__prompt_kernel_p1skip7:
    v_max3_f32 v216, v216, v96, v97
    v_max3_f32 v216, v216, v98, v99
    v_max3_f32 v216, v216, v100, v101
    v_max3_f32 v216, v216, v102, v103
    v_max3_f32 v216, v216, v104, v105
    v_max3_f32 v216, v216, v106, v107
    v_max3_f32 v216, v216, v108, v109
    v_max3_f32 v216, v216, v110, v111
    s_cbranch_scc1 concat_heads__linear_attn_block__sliding_block__prompt_kernel_p1end
    s_waitcnt lgkmcnt(0)
    s_cmp_le_u32 s49, 8
    s_cbranch_scc1 concat_heads__linear_attn_block__sliding_block__prompt_kernel_p1skip8
    v_mfma_f32_32x32x16_bf16 v[128:143], v[168:171], v[160:163], v[200:215]
    v_mfma_f32_32x32x16_bf16 v[128:143], v[172:175], v[164:167], v[128:143]
concat_heads__linear_attn_block__sliding_block__prompt_kernel_p1skip8:
    v_max3_f32 v216, v216, v112, v113
    v_max3_f32 v216, v216, v114, v115
    v_max3_f32 v216, v216, v116, v117
    v_max3_f32 v216, v216, v118, v119
    v_max3_f32 v216, v216, v120, v121
    v_max3_f32 v216, v216, v122, v123
    v_max3_f32 v216, v216, v124, v125
    v_max3_f32 v216, v216, v126, v127
    s_cbranch_scc1 concat_heads__linear_attn_block__sliding_block__prompt_kernel_p1end
    s_nop 3
    v_max3_f32 v216, v216, v128, v129
    v_max3_f32 v216, v216, v130, v131
    v_max3_f32 v216, v216, v132, v133
    v_max3_f32 v216, v216, v134, v135
    v_max3_f32 v216, v216, v136, v137
    v_max3_f32 v216, v216, v138, v139
    v_max3_f32 v216, v216, v140, v141
    v_max3_f32 v216, v216, v142, v143
concat_heads__linear_attn_block__sliding_block__prompt_kernel_p1end:
    s_cmp_lg_u32 s3, 4
    s_cbranch_scc1 concat_heads__linear_attn_block__sliding_block__prompt_kernel_nosig
    s_waitcnt vmcnt(0)
    s_lshl_b32 s18, s44, 4
    s_add_u32 s18, s18, s45
    s_lshl_b32 s18, s18, 3
    s_add_u32 s18, s18, 23658496
    v_mov_b32 v222, 0
    v_mov_b32 v220, s16
    v_mov_b32 v221, s17
    s_mov_b64 exec, 1
    buffer_store_dwordx2 v[220:221], v222, s[8:11], s18 offen sc1
    s_mov_b64 exec, -1
concat_heads__linear_attn_block__sliding_block__prompt_kernel_nosig:
    s_cmp_lt_u32 s3, 6
    s_cbranch_scc1 concat_heads__linear_attn_block__sliding_block__prompt_kernel_vw
    s_waitcnt vmcnt(0)
    v_mov_b32 v220, 0x26824
    v_mov_b32 v221, 1
    s_mov_b64 exec, 1
    ds_add_u32 v220, v221
    s_mov_b64 exec, -1
concat_heads__linear_attn_block__sliding_block__prompt_kernel_vw:
    v_mov_b32 v220, 0x26824
    s_mov_b32 s22, 0
concat_heads__linear_attn_block__sliding_block__prompt_kernel_lw30:
    ds_read_b32 v221, v220
    s_waitcnt lgkmcnt(0)
    v_readfirstlane_b32 s18, v221
    s_add_u32 s22, s22, 1
    s_nop 2
    s_cmp_ge_u32 s18, 2
    s_cbranch_scc1 concat_heads__linear_attn_block__sliding_block__prompt_kernel_lwd31
    s_cmp_ge_u32 s22, 0x1000000
    s_cbranch_scc1 concat_heads__linear_attn_block__sliding_block__prompt_kernel_lwd31
    s_sleep 1
    s_branch concat_heads__linear_attn_block__sliding_block__prompt_kernel_lw30
concat_heads__linear_attn_block__sliding_block__prompt_kernel_lwd31:
    s_waitcnt lgkmcnt(0)
    s_mov_b32 s18, 0x3f803f80
    v_mov_b32 v184, s18
    v_mov_b32 v185, s18
    v_mov_b32 v186, s18
    v_mov_b32 v187, s18
    v_mov_b32 v188, s18
    v_mov_b32 v189, s18
    v_mov_b32 v190, s18
    v_mov_b32 v191, s18
    v_mov_b32 v192, s18
    v_mov_b32 v193, s18
    v_mov_b32 v194, s18
    v_mov_b32 v195, s18
    v_mov_b32 v196, s18
    v_mov_b32 v197, s18
    v_mov_b32 v198, s18
    v_mov_b32 v199, s18
    s_mov_b64 exec, s[50:51]
    ds_read_b128 v[184:187], v230 offset:10240
    ds_read_b128 v[188:191], v230 offset:10880
    s_mov_b64 exec, -1
    v_mov_b32 v222, v216
    v_mov_b32 v223, v216
    s_nop 1
    v_permlane32_swap_b32 v222, v223
    s_nop 1
    v_max_f32 v216, v222, v223
    v_sub_f32 v218, 0, v216
    v_sub_f32 v219, 0, v216
    s_mov_b32 s7, 0
    v_pk_add_f32 v[0:1], v[0:1], v[218:219]
    v_pk_add_f32 v[2:3], v[2:3], v[218:219]
    v_pk_add_f32 v[4:5], v[4:5], v[218:219]
    v_pk_add_f32 v[6:7], v[6:7], v[218:219]
    v_pk_add_f32 v[8:9], v[8:9], v[218:219]
    v_pk_add_f32 v[10:11], v[10:11], v[218:219]
    v_pk_add_f32 v[12:13], v[12:13], v[218:219]
    v_pk_add_f32 v[14:15], v[14:15], v[218:219]
    v_exp_f32 v0, v0
    v_exp_f32 v1, v1
    v_exp_f32 v2, v2
    v_exp_f32 v3, v3
    v_exp_f32 v4, v4
    v_exp_f32 v5, v5
    v_exp_f32 v6, v6
    v_exp_f32 v7, v7
    v_exp_f32 v8, v8
    v_exp_f32 v9, v9
    v_exp_f32 v10, v10
    v_exp_f32 v11, v11
    v_exp_f32 v12, v12
    v_exp_f32 v13, v13
    v_exp_f32 v14, v14
    v_exp_f32 v15, v15
    s_waitcnt lgkmcnt(0)
    s_mov_b64 exec, s[50:51]
    ds_read_b128 v[192:195], v230 offset:8960
    ds_read_b128 v[196:199], v230 offset:9600
    s_mov_b64 exec, -1
    v_cvt_pk_bf16_f32 v0, v0, v1
    v_cvt_pk_bf16_f32 v1, v2, v3
    v_cvt_pk_bf16_f32 v2, v4, v5
    v_cvt_pk_bf16_f32 v3, v6, v7
    v_cvt_pk_bf16_f32 v4, v8, v9
    v_cvt_pk_bf16_f32 v5, v10, v11
    v_cvt_pk_bf16_f32 v6, v12, v13
    v_cvt_pk_bf16_f32 v7, v14, v15
    s_nop 1
    v_mfma_f32_32x32x16_bf16 v[144:159], v[184:187], v[0:3], 0
    v_mfma_f32_32x32x16_bf16 v[144:159], v[188:191], v[4:7], v[144:159]
    v_mov_b32 v224, 0x26808
    s_mov_b32 s22, 0
concat_heads__linear_attn_block__sliding_block__prompt_kernel_lw32:
    ds_read_b32 v225, v224
    s_waitcnt lgkmcnt(0)
    v_readfirstlane_b32 s18, v225
    s_add_u32 s22, s22, 1
    s_nop 2
    s_cmp_ge_u32 s18, 1
    s_cbranch_scc1 concat_heads__linear_attn_block__sliding_block__prompt_kernel_lwd33
    s_cmp_ge_u32 s22, 0x1000000
    s_cbranch_scc1 concat_heads__linear_attn_block__sliding_block__prompt_kernel_lwd33
    s_sleep 1
    s_branch concat_heads__linear_attn_block__sliding_block__prompt_kernel_lw32
concat_heads__linear_attn_block__sliding_block__prompt_kernel_lwd33:
    buffer_load_dwordx4 v[160:163], v228, s[8:11], s63 offen sc1
    buffer_load_dwordx4 v[164:167], v228, s[8:11], s63 offen offset:1024 sc1
    s_mov_b32 s7, 1
    s_cmp_le_u32 s49, 1
    s_cbranch_scc1 concat_heads__linear_attn_block__sliding_block__prompt_kernel_p2end
    v_pk_add_f32 v[16:17], v[16:17], v[218:219]
    v_pk_add_f32 v[18:19], v[18:19], v[218:219]
    v_pk_add_f32 v[20:21], v[20:21], v[218:219]
    v_pk_add_f32 v[22:23], v[22:23], v[218:219]
    v_pk_add_f32 v[24:25], v[24:25], v[218:219]
    v_pk_add_f32 v[26:27], v[26:27], v[218:219]
    v_pk_add_f32 v[28:29], v[28:29], v[218:219]
    v_pk_add_f32 v[30:31], v[30:31], v[218:219]
    v_exp_f32 v16, v16
    v_exp_f32 v17, v17
    v_exp_f32 v18, v18
    v_exp_f32 v19, v19
    v_exp_f32 v20, v20
    v_exp_f32 v21, v21
    v_exp_f32 v22, v22
    v_exp_f32 v23, v23
    v_exp_f32 v24, v24
    v_exp_f32 v25, v25
    v_exp_f32 v26, v26
    v_exp_f32 v27, v27
    v_exp_f32 v28, v28
    v_exp_f32 v29, v29
    v_exp_f32 v30, v30
    v_exp_f32 v31, v31
    s_waitcnt lgkmcnt(0)
    s_mov_b64 exec, s[50:51]
    ds_read_b128 v[184:187], v230 offset:7680
    ds_read_b128 v[188:191], v230 offset:8320
    s_mov_b64 exec, -1
    v_cvt_pk_bf16_f32 v16, v16, v17
    v_cvt_pk_bf16_f32 v17, v18, v19
    v_cvt_pk_bf16_f32 v18, v20, v21
    v_cvt_pk_bf16_f32 v19, v22, v23
    v_cvt_pk_bf16_f32 v20, v24, v25
    v_cvt_pk_bf16_f32 v21, v26, v27
    v_cvt_pk_bf16_f32 v22, v28, v29
    v_cvt_pk_bf16_f32 v23, v30, v31
    s_nop 1
    v_mfma_f32_32x32x16_bf16 v[144:159], v[192:195], v[16:19], v[144:159]
    v_mfma_f32_32x32x16_bf16 v[144:159], v[196:199], v[20:23], v[144:159]
    s_cmp_le_u32 s49, 2
    s_cbranch_scc1 concat_heads__linear_attn_block__sliding_block__prompt_kernel_p2end
    v_pk_add_f32 v[32:33], v[32:33], v[218:219]
    v_pk_add_f32 v[34:35], v[34:35], v[218:219]
    v_pk_add_f32 v[36:37], v[36:37], v[218:219]
    v_pk_add_f32 v[38:39], v[38:39], v[218:219]
    v_pk_add_f32 v[40:41], v[40:41], v[218:219]
    v_pk_add_f32 v[42:43], v[42:43], v[218:219]
    v_pk_add_f32 v[44:45], v[44:45], v[218:219]
    v_pk_add_f32 v[46:47], v[46:47], v[218:219]
    v_exp_f32 v32, v32
    v_exp_f32 v33, v33
    v_exp_f32 v34, v34
    v_exp_f32 v35, v35
    v_exp_f32 v36, v36
    v_exp_f32 v37, v37
    v_exp_f32 v38, v38
    v_exp_f32 v39, v39
    v_exp_f32 v40, v40
    v_exp_f32 v41, v41
    v_exp_f32 v42, v42
    v_exp_f32 v43, v43
    v_exp_f32 v44, v44
    v_exp_f32 v45, v45
    v_exp_f32 v46, v46
    v_exp_f32 v47, v47
    s_waitcnt lgkmcnt(0)
    s_mov_b64 exec, s[50:51]
    ds_read_b128 v[192:195], v230 offset:6400
    ds_read_b128 v[196:199], v230 offset:7040
    s_mov_b64 exec, -1
    v_cvt_pk_bf16_f32 v32, v32, v33
    v_cvt_pk_bf16_f32 v33, v34, v35
    v_cvt_pk_bf16_f32 v34, v36, v37
    v_cvt_pk_bf16_f32 v35, v38, v39
    v_cvt_pk_bf16_f32 v36, v40, v41
    v_cvt_pk_bf16_f32 v37, v42, v43
    v_cvt_pk_bf16_f32 v38, v44, v45
    v_cvt_pk_bf16_f32 v39, v46, v47
    s_nop 1
    v_mfma_f32_32x32x16_bf16 v[144:159], v[184:187], v[32:35], v[144:159]
    v_mfma_f32_32x32x16_bf16 v[144:159], v[188:191], v[36:39], v[144:159]
    s_cmp_le_u32 s49, 3
    s_cbranch_scc1 concat_heads__linear_attn_block__sliding_block__prompt_kernel_p2end
    v_pk_add_f32 v[48:49], v[48:49], v[218:219]
    v_pk_add_f32 v[50:51], v[50:51], v[218:219]
    v_pk_add_f32 v[52:53], v[52:53], v[218:219]
    v_pk_add_f32 v[54:55], v[54:55], v[218:219]
    v_pk_add_f32 v[56:57], v[56:57], v[218:219]
    v_pk_add_f32 v[58:59], v[58:59], v[218:219]
    v_pk_add_f32 v[60:61], v[60:61], v[218:219]
    v_pk_add_f32 v[62:63], v[62:63], v[218:219]
    v_exp_f32 v48, v48
    v_exp_f32 v49, v49
    v_exp_f32 v50, v50
    v_exp_f32 v51, v51
    v_exp_f32 v52, v52
    v_exp_f32 v53, v53
    v_exp_f32 v54, v54
    v_exp_f32 v55, v55
    v_exp_f32 v56, v56
    v_exp_f32 v57, v57
    v_exp_f32 v58, v58
    v_exp_f32 v59, v59
    v_exp_f32 v60, v60
    v_exp_f32 v61, v61
    v_exp_f32 v62, v62
    v_exp_f32 v63, v63
    s_waitcnt lgkmcnt(0)
    s_mov_b64 exec, s[50:51]
    ds_read_b128 v[184:187], v230 offset:5120
    ds_read_b128 v[188:191], v230 offset:5760
    s_mov_b64 exec, -1
    v_cvt_pk_bf16_f32 v48, v48, v49
    v_cvt_pk_bf16_f32 v49, v50, v51
    v_cvt_pk_bf16_f32 v50, v52, v53
    v_cvt_pk_bf16_f32 v51, v54, v55
    v_cvt_pk_bf16_f32 v52, v56, v57
    v_cvt_pk_bf16_f32 v53, v58, v59
    v_cvt_pk_bf16_f32 v54, v60, v61
    v_cvt_pk_bf16_f32 v55, v62, v63
    s_nop 1
    v_mfma_f32_32x32x16_bf16 v[144:159], v[192:195], v[48:51], v[144:159]
    v_mfma_f32_32x32x16_bf16 v[144:159], v[196:199], v[52:55], v[144:159]
    s_cmp_le_u32 s49, 4
    s_cbranch_scc1 concat_heads__linear_attn_block__sliding_block__prompt_kernel_p2end
    v_pk_add_f32 v[64:65], v[64:65], v[218:219]
    v_pk_add_f32 v[66:67], v[66:67], v[218:219]
    v_pk_add_f32 v[68:69], v[68:69], v[218:219]
    v_pk_add_f32 v[70:71], v[70:71], v[218:219]
    v_pk_add_f32 v[72:73], v[72:73], v[218:219]
    v_pk_add_f32 v[74:75], v[74:75], v[218:219]
    v_pk_add_f32 v[76:77], v[76:77], v[218:219]
    v_pk_add_f32 v[78:79], v[78:79], v[218:219]
    v_exp_f32 v64, v64
    v_exp_f32 v65, v65
    v_exp_f32 v66, v66
    v_exp_f32 v67, v67
    v_exp_f32 v68, v68
    v_exp_f32 v69, v69
    v_exp_f32 v70, v70
    v_exp_f32 v71, v71
    v_exp_f32 v72, v72
    v_exp_f32 v73, v73
    v_exp_f32 v74, v74
    v_exp_f32 v75, v75
    v_exp_f32 v76, v76
    v_exp_f32 v77, v77
    v_exp_f32 v78, v78
    v_exp_f32 v79, v79
    s_waitcnt lgkmcnt(0)
    s_mov_b64 exec, s[50:51]
    ds_read_b128 v[192:195], v230 offset:3840
    ds_read_b128 v[196:199], v230 offset:4480
    s_mov_b64 exec, -1
    v_cvt_pk_bf16_f32 v64, v64, v65
    v_cvt_pk_bf16_f32 v65, v66, v67
    v_cvt_pk_bf16_f32 v66, v68, v69
    v_cvt_pk_bf16_f32 v67, v70, v71
    v_cvt_pk_bf16_f32 v68, v72, v73
    v_cvt_pk_bf16_f32 v69, v74, v75
    v_cvt_pk_bf16_f32 v70, v76, v77
    v_cvt_pk_bf16_f32 v71, v78, v79
    s_nop 1
    v_mfma_f32_32x32x16_bf16 v[144:159], v[184:187], v[64:67], v[144:159]
    v_mfma_f32_32x32x16_bf16 v[144:159], v[188:191], v[68:71], v[144:159]
    s_cmp_le_u32 s49, 5
    s_cbranch_scc1 concat_heads__linear_attn_block__sliding_block__prompt_kernel_p2end
    v_pk_add_f32 v[80:81], v[80:81], v[218:219]
    v_pk_add_f32 v[82:83], v[82:83], v[218:219]
    v_pk_add_f32 v[84:85], v[84:85], v[218:219]
    v_pk_add_f32 v[86:87], v[86:87], v[218:219]
    v_pk_add_f32 v[88:89], v[88:89], v[218:219]
    v_pk_add_f32 v[90:91], v[90:91], v[218:219]
    v_pk_add_f32 v[92:93], v[92:93], v[218:219]
    v_pk_add_f32 v[94:95], v[94:95], v[218:219]
    v_exp_f32 v80, v80
    v_exp_f32 v81, v81
    v_exp_f32 v82, v82
    v_exp_f32 v83, v83
    v_exp_f32 v84, v84
    v_exp_f32 v85, v85
    v_exp_f32 v86, v86
    v_exp_f32 v87, v87
    v_exp_f32 v88, v88
    v_exp_f32 v89, v89
    v_exp_f32 v90, v90
    v_exp_f32 v91, v91
    v_exp_f32 v92, v92
    v_exp_f32 v93, v93
    v_exp_f32 v94, v94
    v_exp_f32 v95, v95
    s_waitcnt lgkmcnt(0)
    s_mov_b64 exec, s[50:51]
    ds_read_b128 v[184:187], v230 offset:2560
    ds_read_b128 v[188:191], v230 offset:3200
    s_mov_b64 exec, -1
    v_cvt_pk_bf16_f32 v80, v80, v81
    v_cvt_pk_bf16_f32 v81, v82, v83
    v_cvt_pk_bf16_f32 v82, v84, v85
    v_cvt_pk_bf16_f32 v83, v86, v87
    v_cvt_pk_bf16_f32 v84, v88, v89
    v_cvt_pk_bf16_f32 v85, v90, v91
    v_cvt_pk_bf16_f32 v86, v92, v93
    v_cvt_pk_bf16_f32 v87, v94, v95
    s_nop 1
    v_mfma_f32_32x32x16_bf16 v[144:159], v[192:195], v[80:83], v[144:159]
    v_mfma_f32_32x32x16_bf16 v[144:159], v[196:199], v[84:87], v[144:159]
    s_cmp_le_u32 s49, 6
    s_cbranch_scc1 concat_heads__linear_attn_block__sliding_block__prompt_kernel_p2end
    v_pk_add_f32 v[96:97], v[96:97], v[218:219]
    v_pk_add_f32 v[98:99], v[98:99], v[218:219]
    v_pk_add_f32 v[100:101], v[100:101], v[218:219]
    v_pk_add_f32 v[102:103], v[102:103], v[218:219]
    v_pk_add_f32 v[104:105], v[104:105], v[218:219]
    v_pk_add_f32 v[106:107], v[106:107], v[218:219]
    v_pk_add_f32 v[108:109], v[108:109], v[218:219]
    v_pk_add_f32 v[110:111], v[110:111], v[218:219]
    v_exp_f32 v96, v96
    v_exp_f32 v97, v97
    v_exp_f32 v98, v98
    v_exp_f32 v99, v99
    v_exp_f32 v100, v100
    v_exp_f32 v101, v101
    v_exp_f32 v102, v102
    v_exp_f32 v103, v103
    v_exp_f32 v104, v104
    v_exp_f32 v105, v105
    v_exp_f32 v106, v106
    v_exp_f32 v107, v107
    v_exp_f32 v108, v108
    v_exp_f32 v109, v109
    v_exp_f32 v110, v110
    v_exp_f32 v111, v111
    s_waitcnt lgkmcnt(0)
    s_mov_b64 exec, s[50:51]
    ds_read_b128 v[192:195], v230 offset:1280
    ds_read_b128 v[196:199], v230 offset:1920
    s_mov_b64 exec, -1
    v_cvt_pk_bf16_f32 v96, v96, v97
    v_cvt_pk_bf16_f32 v97, v98, v99
    v_cvt_pk_bf16_f32 v98, v100, v101
    v_cvt_pk_bf16_f32 v99, v102, v103
    v_cvt_pk_bf16_f32 v100, v104, v105
    v_cvt_pk_bf16_f32 v101, v106, v107
    v_cvt_pk_bf16_f32 v102, v108, v109
    v_cvt_pk_bf16_f32 v103, v110, v111
    s_nop 1
    v_mfma_f32_32x32x16_bf16 v[144:159], v[184:187], v[96:99], v[144:159]
    v_mfma_f32_32x32x16_bf16 v[144:159], v[188:191], v[100:103], v[144:159]
    s_cmp_le_u32 s49, 7
    s_cbranch_scc1 concat_heads__linear_attn_block__sliding_block__prompt_kernel_p2end
    v_pk_add_f32 v[112:113], v[112:113], v[218:219]
    v_pk_add_f32 v[114:115], v[114:115], v[218:219]
    v_pk_add_f32 v[116:117], v[116:117], v[218:219]
    v_pk_add_f32 v[118:119], v[118:119], v[218:219]
    v_pk_add_f32 v[120:121], v[120:121], v[218:219]
    v_pk_add_f32 v[122:123], v[122:123], v[218:219]
    v_pk_add_f32 v[124:125], v[124:125], v[218:219]
    v_pk_add_f32 v[126:127], v[126:127], v[218:219]
    v_exp_f32 v112, v112
    v_exp_f32 v113, v113
    v_exp_f32 v114, v114
    v_exp_f32 v115, v115
    v_exp_f32 v116, v116
    v_exp_f32 v117, v117
    v_exp_f32 v118, v118
    v_exp_f32 v119, v119
    v_exp_f32 v120, v120
    v_exp_f32 v121, v121
    v_exp_f32 v122, v122
    v_exp_f32 v123, v123
    v_exp_f32 v124, v124
    v_exp_f32 v125, v125
    v_exp_f32 v126, v126
    v_exp_f32 v127, v127
    s_waitcnt lgkmcnt(0)
    s_mov_b64 exec, s[50:51]
    ds_read_b128 v[184:187], v230 offset:0
    ds_read_b128 v[188:191], v230 offset:640
    s_mov_b64 exec, -1
    v_cvt_pk_bf16_f32 v112, v112, v113
    v_cvt_pk_bf16_f32 v113, v114, v115
    v_cvt_pk_bf16_f32 v114, v116, v117
    v_cvt_pk_bf16_f32 v115, v118, v119
    v_cvt_pk_bf16_f32 v116, v120, v121
    v_cvt_pk_bf16_f32 v117, v122, v123
    v_cvt_pk_bf16_f32 v118, v124, v125
    v_cvt_pk_bf16_f32 v119, v126, v127
    s_nop 1
    v_mfma_f32_32x32x16_bf16 v[144:159], v[192:195], v[112:115], v[144:159]
    v_mfma_f32_32x32x16_bf16 v[144:159], v[196:199], v[116:119], v[144:159]
    s_cmp_le_u32 s49, 8
    s_cbranch_scc1 concat_heads__linear_attn_block__sliding_block__prompt_kernel_p2end
    v_pk_add_f32 v[128:129], v[128:129], v[218:219]
    v_pk_add_f32 v[130:131], v[130:131], v[218:219]
    v_pk_add_f32 v[132:133], v[132:133], v[218:219]
    v_pk_add_f32 v[134:135], v[134:135], v[218:219]
    v_pk_add_f32 v[136:137], v[136:137], v[218:219]
    v_pk_add_f32 v[138:139], v[138:139], v[218:219]
    v_pk_add_f32 v[140:141], v[140:141], v[218:219]
    v_pk_add_f32 v[142:143], v[142:143], v[218:219]
    v_exp_f32 v128, v128
    v_exp_f32 v129, v129
    v_exp_f32 v130, v130
    v_exp_f32 v131, v131
    v_exp_f32 v132, v132
    v_exp_f32 v133, v133
    v_exp_f32 v134, v134
    v_exp_f32 v135, v135
    v_exp_f32 v136, v136
    v_exp_f32 v137, v137
    v_exp_f32 v138, v138
    v_exp_f32 v139, v139
    v_exp_f32 v140, v140
    v_exp_f32 v141, v141
    v_exp_f32 v142, v142
    v_exp_f32 v143, v143
    s_waitcnt lgkmcnt(0)
    v_cvt_pk_bf16_f32 v128, v128, v129
    v_cvt_pk_bf16_f32 v129, v130, v131
    v_cvt_pk_bf16_f32 v130, v132, v133
    v_cvt_pk_bf16_f32 v131, v134, v135
    v_cvt_pk_bf16_f32 v132, v136, v137
    v_cvt_pk_bf16_f32 v133, v138, v139
    v_cvt_pk_bf16_f32 v134, v140, v141
    v_cvt_pk_bf16_f32 v135, v142, v143
    s_nop 1
    v_mfma_f32_32x32x16_bf16 v[144:159], v[184:187], v[128:131], v[144:159]
    v_mfma_f32_32x32x16_bf16 v[144:159], v[188:191], v[132:135], v[144:159]
concat_heads__linear_attn_block__sliding_block__prompt_kernel_p2end:
    s_mov_b32 s68, 0x358637bd
    s_cmp_ge_u32 s3, 4
    s_cbranch_scc1 concat_heads__linear_attn_block__sliding_block__prompt_kernel_hiwaves
    s_lshl_b32 s23, s44, 7
    s_add_u32 s23, s23, 23658496
    s_cmp_lg_u32 s3, 0
    s_cbranch_scc1 concat_heads__linear_attn_block__sliding_block__prompt_kernel_w123
    s_mov_b32 exec_lo, 0xff
    s_mov_b32 exec_hi, 0
    buffer_load_dwordx2 v[224:225], v242, s[8:11], s23 offen sc1
    s_mov_b64 exec, -1
    s_nop 7
    s_nop 3
    v_mov_b32 v220, v152
    v_mov_b32 v221, v152
    s_nop 1
    v_permlane32_swap_b32 v220, v221
    s_nop 1
    v_rcp_f32 v221, v221
    s_nop 0
    v_mul_f32 v144, v221, v144
    v_mul_f32 v145, v221, v145
    v_mul_f32 v146, v221, v146
    v_mul_f32 v147, v221, v147
    v_mul_f32 v148, v221, v148
    v_mul_f32 v149, v221, v149
    v_mul_f32 v150, v221, v150
    v_mul_f32 v151, v221, v151
    v_mul_f32 v152, v221, v152
    v_mul_f32 v153, v221, v153
    v_mul_f32 v154, v221, v154
    v_mul_f32 v155, v221, v155
    v_cvt_pk_bf16_f32 v236, v144, v145
    v_cvt_pk_bf16_f32 v237, v146, v147
    v_cvt_pk_bf16_f32 v238, v148, v149
    v_cvt_pk_bf16_f32 v239, v150, v151
    v_cvt_pk_bf16_f32 v240, v152, v153
    v_cvt_pk_bf16_f32 v241, v154, v155
    s_mov_b32 s32, 0xff
    s_mov_b32 s33, 0x0
    s_mov_b32 s22, 0
concat_heads__linear_attn_block__sliding_block__prompt_kernel_poll34:
    s_waitcnt vmcnt(0)
    v_cmp_eq_u32 vcc, s16, v224
    v_cmp_eq_u32 s[34:35], s17, v225
    s_add_u32 s22, s22, 1
    s_nop 3
    s_and_b64 s[34:35], s[34:35], vcc
    s_and_b64 s[34:35], s[34:35], s[32:33]
    s_cmp_eq_u64 s[34:35], s[32:33]
    s_cbranch_scc1 concat_heads__linear_attn_block__sliding_block__prompt_kernel_polld35
    s_cmp_ge_u32 s22, 0x100000
    s_cbranch_scc1 concat_heads__linear_attn_block__sliding_block__prompt_kernel_polld35
    s_sleep 3
    s_mov_b32 exec_lo, 0xff
    s_mov_b32 exec_hi, 0
    buffer_load_dwordx2 v[224:225], v242, s[8:11], s23 offen sc1
    s_mov_b64 exec, -1
    s_branch concat_heads__linear_attn_block__sliding_block__prompt_kernel_poll34
concat_heads__linear_attn_block__sliding_block__prompt_kernel_polld35:
    v_mov_b32 v224, 0x2680c
    v_mov_b32 v225, 1
    ds_write_b32 v224, v225
    s_branch concat_heads__linear_attn_block__sliding_block__prompt_kernel_w0123
concat_heads__linear_attn_block__sliding_block__prompt_kernel_w123:
    s_nop 7
    s_nop 3
    v_mov_b32 v220, v152
    v_mov_b32 v221, v152
    s_nop 1
    v_permlane32_swap_b32 v220, v221
    s_nop 1
    v_rcp_f32 v221, v221
    s_nop 0
    v_mul_f32 v144, v221, v144
    v_mul_f32 v145, v221, v145
    v_mul_f32 v146, v221, v146
    v_mul_f32 v147, v221, v147
    v_mul_f32 v148, v221, v148
    v_mul_f32 v149, v221, v149
    v_mul_f32 v150, v221, v150
    v_mul_f32 v151, v221, v151
    v_mul_f32 v152, v221, v152
    v_mul_f32 v153, v221, v153
    v_mul_f32 v154, v221, v154
    v_mul_f32 v155, v221, v155
    v_cvt_pk_bf16_f32 v236, v144, v145
    v_cvt_pk_bf16_f32 v237, v146, v147
    v_cvt_pk_bf16_f32 v238, v148, v149
    v_cvt_pk_bf16_f32 v239, v150, v151
    v_cvt_pk_bf16_f32 v240, v152, v153
    v_cvt_pk_bf16_f32 v241, v154, v155
    v_mov_b32 v224, 0x2680c
    s_mov_b32 s22, 0
concat_heads__linear_attn_block__sliding_block__prompt_kernel_lw36:
    ds_read_b32 v225, v224
    s_waitcnt lgkmcnt(0)
    v_readfirstlane_b32 s18, v225
    s_add_u32 s22, s22, 1
    s_nop 2
    s_cmp_ge_u32 s18, 1
    s_cbranch_scc1 concat_heads__linear_attn_block__sliding_block__prompt_kernel_lwd37
    s_cmp_ge_u32 s22, 0x1000000
    s_cbranch_scc1 concat_heads__linear_attn_block__sliding_block__prompt_kernel_lwd37
    s_sleep 1
    s_branch concat_heads__linear_attn_block__sliding_block__prompt_kernel_lw36
concat_heads__linear_attn_block__sliding_block__prompt_kernel_lwd37:
concat_heads__linear_attn_block__sliding_block__prompt_kernel_w0123:
    s_lshl_b32 s18, s3, 1
    s_sub_u32 s18, s18, s47
    v_lshrrev_b32 v220, 5, v231
    v_add_u32 v220, s18, v220
    v_and_b32 v221, 31, v231
    v_lshlrev_b32 v221, 4, v221
    v_lshl_add_u32 v221, v220, 9, v221
    v_cmp_ge_u32 vcc, 4, v220
    v_mov_b32 v222, 0x40000000
    s_nop 0
    v_cndmask_b32 v235, v222, v221, vcc
    s_lshl_b32 s18, s44, 3
    s_mul_i32 s18, s18, 3072
    s_add_u32 s18, s18, 20971520
    buffer_load_dwordx4 v[0:3], v235, s[8:11], s18 offen sc1
    s_add_u32 s18, s18, 3072
    buffer_load_dwordx4 v[4:7], v235, s[8:11], s18 offen sc1
    s_add_u32 s18, s18, 3072
    buffer_load_dwordx4 v[8:11], v235, s[8:11], s18 offen sc1
    s_add_u32 s18, s18, 3072
    buffer_load_dwordx4 v[12:15], v235, s[8:11], s18 offen sc1
    s_add_u32 s18, s18, 3072
    buffer_load_dwordx4 v[16:19], v235, s[8:11], s18 offen sc1
    s_add_u32 s18, s18, 3072
    buffer_load_dwordx4 v[20:23], v235, s[8:11], s18 offen sc1
    s_add_u32 s18, s18, 3072
    buffer_load_dwordx4 v[24:27], v235, s[8:11], s18 offen sc1
    s_add_u32 s18, s18, 3072
    buffer_load_dwordx4 v[28:31], v235, s[8:11], s18 offen sc1
    s_add_u32 s18, s62, 18350080
    buffer_store_dwordx4 v[236:239], v232, s[8:11], s18 offen sc1
    buffer_store_dwordx2 v[240:241], v233, s[8:11], s18 offen sc1
    s_waitcnt vmcnt(2)
    v_add_f32 v0, v0, v4
    v_add_f32 v1, v1, v5
    v_add_f32 v2, v2, v6
    v_add_f32 v3, v3, v7
    v_add_f32 v0, v0, v8
    v_add_f32 v1, v1, v9
    v_add_f32 v2, v2, v10
    v_add_f32 v3, v3, v11
    v_add_f32 v0, v0, v12
    v_add_f32 v1, v1, v13
    v_add_f32 v2, v2, v14
    v_add_f32 v3, v3, v15
    v_add_f32 v0, v0, v16
    v_add_f32 v1, v1, v17
    v_add_f32 v2, v2, v18
    v_add_f32 v3, v3, v19
    v_add_f32 v0, v0, v20
    v_add_f32 v1, v1, v21
    v_add_f32 v2, v2, v22
    v_add_f32 v3, v3, v23
    v_add_f32 v0, v0, v24
    v_add_f32 v1, v1, v25
    v_add_f32 v2, v2, v26
    v_add_f32 v3, v3, v27
    v_add_f32 v0, v0, v28
    v_add_f32 v1, v1, v29
    v_add_f32 v2, v2, v30
    v_add_f32 v3, v3, v31
    v_cvt_pk_bf16_f32 v220, v0, v1
    v_cvt_pk_bf16_f32 v221, v2, v3
    s_lshr_b32 s18, s3, 1
    s_lshl_b32 s18, s18, 10
    s_and_b32 s19, s3, 1
    s_lshl_b32 s19, s19, 3
    s_add_u32 s18, s18, s19
    s_add_u32 s18, s18, 155648
    v_add_u32 v235, s18, v228
    ds_write_b64 v235, v[220:221]
    s_branch concat_heads__linear_attn_block__sliding_block__prompt_kernel_join
concat_heads__linear_attn_block__sliding_block__prompt_kernel_hiwaves:
    s_nop 7
    s_nop 3
    v_mov_b32 v220, v152
    v_mov_b32 v221, v152
    s_nop 1
    v_permlane32_swap_b32 v220, v221
    s_nop 1
    v_rcp_f32 v221, v221
    s_nop 0
    v_mul_f32 v144, v221, v144
    v_mul_f32 v145, v221, v145
    v_mul_f32 v146, v221, v146
    v_mul_f32 v147, v221, v147
    v_mul_f32 v148, v221, v148
    v_mul_f32 v149, v221, v149
    v_mul_f32 v150, v221, v150
    v_mul_f32 v151, v221, v151
    v_mul_f32 v152, v221, v152
    v_mul_f32 v153, v221, v153
    v_mul_f32 v154, v221, v154
    v_mul_f32 v155, v221, v155
    v_cvt_pk_bf16_f32 v236, v144, v145
    v_cvt_pk_bf16_f32 v237, v146, v147
    v_cvt_pk_bf16_f32 v238, v148, v149
    v_cvt_pk_bf16_f32 v239, v150, v151
    v_cvt_pk_bf16_f32 v240, v152, v153
    v_cvt_pk_bf16_f32 v241, v154, v155
    s_add_u32 s18, s62, 18350080
    buffer_store_dwordx4 v[236:239], v232, s[8:11], s18 offen sc1
    buffer_store_dwordx2 v[240:241], v233, s[8:11], s18 offen sc1
concat_heads__linear_attn_block__sliding_block__prompt_kernel_join:
    s_waitcnt lgkmcnt(0)
    s_barrier
    v_add_u32 v235, 0x26000, v228
    ds_read_b128 v[168:171], v235
    ds_read_b128 v[172:175], v235 offset:1024
    s_lshl_b32 s69, s45, 5
    s_add_u32 s69, s69, s44
    s_lshl_b32 s69, s69, 3
    s_add_u32 s69, s69, 23666688
    s_waitcnt vmcnt(2) lgkmcnt(0)
    v_mfma_f32_32x32x16_bf16 v[144:159], v[168:171], v[160:163], 0
    v_mfma_f32_32x32x16_bf16 v[144:159], v[172:175], v[164:167], v[144:159]
    s_nop 7
    s_nop 3
    v_mov_b32 v220, v152
    v_mov_b32 v221, v152
    s_nop 1
    v_permlane32_swap_b32 v220, v221
    s_nop 1
    v_add_f32 v221, s68, v221
    v_rcp_f32 v221, v221
    s_nop 0
    v_mul_f32 v144, v221, v144
    v_mul_f32 v145, v221, v145
    v_mul_f32 v146, v221, v146
    v_mul_f32 v147, v221, v147
    v_mul_f32 v148, v221, v148
    v_mul_f32 v149, v221, v149
    v_mul_f32 v150, v221, v150
    v_mul_f32 v151, v221, v151
    v_mul_f32 v152, v221, v152
    v_mul_f32 v153, v221, v153
    v_mul_f32 v154, v221, v154
    v_mul_f32 v155, v221, v155
    v_cvt_pk_bf16_f32 v168, v144, v145
    v_cvt_pk_bf16_f32 v169, v146, v147
    v_cvt_pk_bf16_f32 v170, v148, v149
    v_cvt_pk_bf16_f32 v171, v150, v151
    v_cvt_pk_bf16_f32 v172, v152, v153
    v_cvt_pk_bf16_f32 v173, v154, v155
    s_add_u32 s18, s62, 15728640
    buffer_store_dwordx4 v[168:171], v232, s[8:11], s18 offen sc1
    buffer_store_dwordx2 v[172:173], v233, s[8:11], s18 offen sc1
    s_add_u32 s19, s69, 2048
    s_waitcnt vmcnt(2)
    v_mov_b32 v226, 0x26810
    v_mov_b32 v224, 1
    s_mov_b64 exec, 1
    ds_add_rtn_u32 v224, v226, v224
    s_waitcnt lgkmcnt(0)
    s_mov_b64 exec, -1
    v_readfirstlane_b32 s22, v224
    s_nop 3
    s_cmp_lg_u32 s22, 7
    s_cbranch_scc1 concat_heads__linear_attn_block__sliding_block__prompt_kernel_arr38
    v_mbcnt_lo_u32_b32 v226, -1, 0
    v_mbcnt_hi_u32_b32 v226, -1, v226
    v_lshlrev_b32 v226, 12, v226
    v_mov_b32 v224, s16
    v_mov_b32 v225, s17
    s_mov_b32 exec_lo, 0xff
    s_mov_b32 exec_hi, 0
    buffer_store_dwordx2 v[224:225], v226, s[8:11], s19 offen sc1
    s_mov_b64 exec, -1
concat_heads__linear_attn_block__sliding_block__prompt_kernel_arr38:
    s_waitcnt vmcnt(0)
    v_mov_b32 v226, 0x26814
    v_mov_b32 v224, 1
    s_mov_b64 exec, 1
    ds_add_rtn_u32 v224, v226, v224
    s_waitcnt lgkmcnt(0)
    s_mov_b64 exec, -1
    v_readfirstlane_b32 s22, v224
    s_nop 3
    s_cmp_lg_u32 s22, 7
    s_cbranch_scc1 concat_heads__linear_attn_block__sliding_block__prompt_kernel_arr39
    v_mbcnt_lo_u32_b32 v226, -1, 0
    v_mbcnt_hi_u32_b32 v226, -1, v226
    v_lshlrev_b32 v226, 12, v226
    v_mov_b32 v224, s16
    v_mov_b32 v225, s17
    s_mov_b32 exec_lo, 0xff
    s_mov_b32 exec_hi, 0
    buffer_store_dwordx2 v[224:225], v226, s[8:11], s69 offen sc1
    s_mov_b64 exec, -1
concat_heads__linear_attn_block__sliding_block__prompt_kernel_arr39:
    s_cmp_ge_u32 s3, 4
    s_cbranch_scc1 concat_heads__linear_attn_block__sliding_block__prompt_kernel_fin
    s_lshr_b32 s64, s70, 2
    s_and_b32 s18, s70, 3
    s_lshl_b32 s18, s18, 2
    s_lshr_b32 s65, s71, 3
    s_add_u32 s65, s65, s18
    s_and_b32 s66, s71, 7
    s_load_dwordx2 s[4:5], s[0:1], 48
    s_lshl_b32 s44, s65, 2
    s_add_u32 s44, s44, s3
    v_mbcnt_lo_u32_b32 v251, -1, 0
    v_mbcnt_hi_u32_b32 v251, -1, v251
    v_lshlrev_b32 v254, 3, v251
    s_lshl_b32 s18, s64, 3
    s_lshr_b32 s19, s65, 1
    s_add_u32 s18, s18, s19
    s_lshl_b32 s18, s18, 8
    s_and_b32 s19, s66, 7
    s_lshl_b32 s19, s19, 12
    s_add_u32 s18, s18, s19
    s_add_u32 s23, s18, 23666688
    v_lshrrev_b32 v252, 4, v251
    v_and_b32 v253, 15, v251
    v_lshrrev_b32 v248, 1, v252
    v_mul_u32_u24 v245, 1280, v248
    v_and_b32 v248, 1, v252
    v_lshl_add_u32 v245, v248, 9, v245
    v_lshl_add_u32 v245, v253, 4, v245
    v_mul_u32_u24 v246, 1280, v252
    v_lshl_add_u32 v246, v253, 3, v246
    v_add_u32 v246, 1024, v246
    v_bfe_u32 v253, v251, 2, 2
    v_lshrrev_b32 v248, 1, v252
    v_mul_u32_u24 v247, 20, v248
    v_and_b32 v248, 1, v252
    v_lshl_add_u32 v247, v248, 2, v247
    v_add_u32 v247, v247, v253
    v_mul_u32_u24 v247, 160, v247
    v_mul_u32_u24 v249, 20, v252
    v_add_u32 v249, v249, v253
    v_add_u32 v249, 16, v249
    v_mul_u32_u24 v249, 160, v249
    v_and_b32 v248, 3, v251
    v_lshl_add_u32 v247, v248, 3, v247
    v_lshl_add_u32 v249, v248, 3, v249
    v_add_u32 v248, 51200, v247
    v_add_u32 v250, 51200, v249
    s_mul_i32 s45, s64, 2621440
    s_add_u32 s45, s45, 15728640
    s_mul_i32 s18, s44, 40960
    s_add_u32 s45, s45, s18
    s_waitcnt lgkmcnt(0)
    s_mov_b32 s28, s4
    s_and_b32 s29, s5, 0xffff
    s_mov_b32 s30, 0x500000
    s_mov_b32 s31, 0x20000
    s_cmp_lg_u32 s3, 0
    s_cbranch_scc1 concat_heads__linear_attn_block__sliding_block__prompt_kernel_p3w
    s_mov_b32 s32, 0xffffffff
    s_mov_b32 s33, 0x0
    s_mov_b32 exec_lo, 0xffffffff
    s_mov_b32 exec_hi, 0
    buffer_load_dwordx2 v[240:241], v254, s[8:11], s23 offen sc1
    s_mov_b64 exec, -1
    s_mov_b32 s22, 0
concat_heads__linear_attn_block__sliding_block__prompt_kernel_poll40:
    s_waitcnt vmcnt(0)
    v_cmp_eq_u32 vcc, s16, v240
    v_cmp_eq_u32 s[34:35], s17, v241
    s_add_u32 s22, s22, 1
    s_nop 3
    s_and_b64 s[34:35], s[34:35], vcc
    s_and_b64 s[34:35], s[34:35], s[32:33]
    s_cmp_eq_u64 s[34:35], s[32:33]
    s_cbranch_scc1 concat_heads__linear_attn_block__sliding_block__prompt_kernel_polld41
    s_cmp_ge_u32 s22, 0x100000
    s_cbranch_scc1 concat_heads__linear_attn_block__sliding_block__prompt_kernel_polld41
    s_sleep 3
    s_mov_b32 exec_lo, 0xffffffff
    s_mov_b32 exec_hi, 0
    buffer_load_dwordx2 v[240:241], v254, s[8:11], s23 offen sc1
    s_mov_b64 exec, -1
    s_branch concat_heads__linear_attn_block__sliding_block__prompt_kernel_poll40
concat_heads__linear_attn_block__sliding_block__prompt_kernel_polld41:
    v_mov_b32 v252, 0x26818
    v_mov_b32 v253, 1
    ds_write_b32 v252, v253
    s_branch concat_heads__linear_attn_block__sliding_block__prompt_kernel_p3go
concat_heads__linear_attn_block__sliding_block__prompt_kernel_p3w:
    v_mov_b32 v240, 0x26818
    s_mov_b32 s22, 0
concat_heads__linear_attn_block__sliding_block__prompt_kernel_lw42:
    ds_read_b32 v241, v240
    s_waitcnt lgkmcnt(0)
    v_readfirstlane_b32 s18, v241
    s_add_u32 s22, s22, 1
    s_nop 2
    s_cmp_ge_u32 s18, 1
    s_cbranch_scc1 concat_heads__linear_attn_block__sliding_block__prompt_kernel_lwd43
    s_cmp_ge_u32 s22, 0x1000000
    s_cbranch_scc1 concat_heads__linear_attn_block__sliding_block__prompt_kernel_lwd43
    s_sleep 1
    s_branch concat_heads__linear_attn_block__sliding_block__prompt_kernel_lw42
concat_heads__linear_attn_block__sliding_block__prompt_kernel_lwd43:
concat_heads__linear_attn_block__sliding_block__prompt_kernel_p3go:
    s_add_u32 s46, s45, 0
    buffer_load_dwordx4 v[0:3], v245, s[8:11], s46 offen offset:0 sc1
    buffer_load_dwordx4 v[4:7], v245, s[8:11], s46 offen offset:256 sc1
    s_add_u32 s46, s45, 2560
    buffer_load_dwordx4 v[8:11], v245, s[8:11], s46 offen offset:0 sc1
    buffer_load_dwordx4 v[12:15], v245, s[8:11], s46 offen offset:256 sc1
    s_add_u32 s46, s45, 5120
    buffer_load_dwordx4 v[16:19], v245, s[8:11], s46 offen offset:0 sc1
    buffer_load_dwordx4 v[20:23], v245, s[8:11], s46 offen offset:256 sc1
    s_add_u32 s46, s45, 7680
    buffer_load_dwordx4 v[24:27], v245, s[8:11], s46 offen offset:0 sc1
    buffer_load_dwordx4 v[28:31], v245, s[8:11], s46 offen offset:256 sc1
    s_add_u32 s46, s45, 10240
    buffer_load_dwordx4 v[32:35], v245, s[8:11], s46 offen offset:0 sc1
    buffer_load_dwordx4 v[36:39], v245, s[8:11], s46 offen offset:256 sc1
    ds_read_b64_tr_b16 v[200:201], v247 offset:0
    ds_read_b64_tr_b16 v[202:203], v247 offset:1280
    ds_read_b64_tr_b16 v[204:205], v247 offset:32
    ds_read_b64_tr_b16 v[206:207], v247 offset:1312
    ds_read_b64_tr_b16 v[208:209], v247 offset:64
    ds_read_b64_tr_b16 v[210:211], v247 offset:1344
    ds_read_b64_tr_b16 v[212:213], v247 offset:96
    ds_read_b64_tr_b16 v[214:215], v247 offset:1376
    ds_read_b64_tr_b16 v[216:217], v247 offset:128
    ds_read_b64_tr_b16 v[218:219], v247 offset:1408
    s_waitcnt vmcnt(8) lgkmcnt(0)
    v_mfma_f32_16x16x32_bf16 v[160:163], v[200:203], v[0:3], 0
    ds_read_b64_tr_b16 v[220:221], v247 offset:6400
    ds_read_b64_tr_b16 v[222:223], v247 offset:7680
    v_mfma_f32_16x16x32_bf16 v[180:183], v[200:203], v[4:7], 0
    ds_read_b64_tr_b16 v[224:225], v247 offset:6432
    ds_read_b64_tr_b16 v[226:227], v247 offset:7712
    v_mfma_f32_16x16x32_bf16 v[164:167], v[204:207], v[0:3], 0
    ds_read_b64_tr_b16 v[228:229], v247 offset:6464
    ds_read_b64_tr_b16 v[230:231], v247 offset:7744
    v_mfma_f32_16x16x32_bf16 v[184:187], v[204:207], v[4:7], 0
    ds_read_b64_tr_b16 v[232:233], v247 offset:6496
    ds_read_b64_tr_b16 v[234:235], v247 offset:7776
    v_mfma_f32_16x16x32_bf16 v[168:171], v[208:211], v[0:3], 0
    ds_read_b64_tr_b16 v[236:237], v247 offset:6528
    ds_read_b64_tr_b16 v[238:239], v247 offset:7808
    v_mfma_f32_16x16x32_bf16 v[188:191], v[208:211], v[4:7], 0
    s_add_u32 s46, s45, 12800
    buffer_load_dwordx4 v[40:43], v245, s[8:11], s46 offen offset:0 sc1
    buffer_load_dwordx4 v[44:47], v245, s[8:11], s46 offen offset:256 sc1
    v_mfma_f32_16x16x32_bf16 v[172:175], v[212:215], v[0:3], 0
    v_mfma_f32_16x16x32_bf16 v[192:195], v[212:215], v[4:7], 0
    v_mfma_f32_16x16x32_bf16 v[176:179], v[216:219], v[0:3], 0
    v_mfma_f32_16x16x32_bf16 v[196:199], v[216:219], v[4:7], 0
    s_waitcnt vmcnt(8) lgkmcnt(0)
    v_mfma_f32_16x16x32_bf16 v[160:163], v[220:223], v[8:11], v[160:163]
    ds_read_b64_tr_b16 v[200:201], v247 offset:12800
    ds_read_b64_tr_b16 v[202:203], v247 offset:14080
    v_mfma_f32_16x16x32_bf16 v[180:183], v[220:223], v[12:15], v[180:183]
    ds_read_b64_tr_b16 v[204:205], v247 offset:12832
    ds_read_b64_tr_b16 v[206:207], v247 offset:14112
    v_mfma_f32_16x16x32_bf16 v[164:167], v[224:227], v[8:11], v[164:167]
    ds_read_b64_tr_b16 v[208:209], v247 offset:12864
    ds_read_b64_tr_b16 v[210:211], v247 offset:14144
    v_mfma_f32_16x16x32_bf16 v[184:187], v[224:227], v[12:15], v[184:187]
    ds_read_b64_tr_b16 v[212:213], v247 offset:12896
    ds_read_b64_tr_b16 v[214:215], v247 offset:14176
    v_mfma_f32_16x16x32_bf16 v[168:171], v[228:231], v[8:11], v[168:171]
    ds_read_b64_tr_b16 v[216:217], v247 offset:12928
    ds_read_b64_tr_b16 v[218:219], v247 offset:14208
    v_mfma_f32_16x16x32_bf16 v[188:191], v[228:231], v[12:15], v[188:191]
    s_add_u32 s46, s45, 15360
    buffer_load_dwordx4 v[48:51], v245, s[8:11], s46 offen offset:0 sc1
    buffer_load_dwordx4 v[52:55], v245, s[8:11], s46 offen offset:256 sc1
    v_mfma_f32_16x16x32_bf16 v[172:175], v[232:235], v[8:11], v[172:175]
    v_mfma_f32_16x16x32_bf16 v[192:195], v[232:235], v[12:15], v[192:195]
    v_mfma_f32_16x16x32_bf16 v[176:179], v[236:239], v[8:11], v[176:179]
    v_mfma_f32_16x16x32_bf16 v[196:199], v[236:239], v[12:15], v[196:199]
    s_waitcnt vmcnt(8) lgkmcnt(0)
    v_mfma_f32_16x16x32_bf16 v[160:163], v[200:203], v[16:19], v[160:163]
    ds_read_b64_tr_b16 v[220:221], v247 offset:19200
    ds_read_b64_tr_b16 v[222:223], v247 offset:20480
    v_mfma_f32_16x16x32_bf16 v[180:183], v[200:203], v[20:23], v[180:183]
    ds_read_b64_tr_b16 v[224:225], v247 offset:19232
    ds_read_b64_tr_b16 v[226:227], v247 offset:20512
    v_mfma_f32_16x16x32_bf16 v[164:167], v[204:207], v[16:19], v[164:167]
    ds_read_b64_tr_b16 v[228:229], v247 offset:19264
    ds_read_b64_tr_b16 v[230:231], v247 offset:20544
    v_mfma_f32_16x16x32_bf16 v[184:187], v[204:207], v[20:23], v[184:187]
    ds_read_b64_tr_b16 v[232:233], v247 offset:19296
    ds_read_b64_tr_b16 v[234:235], v247 offset:20576
    v_mfma_f32_16x16x32_bf16 v[168:171], v[208:211], v[16:19], v[168:171]
    ds_read_b64_tr_b16 v[236:237], v247 offset:19328
    ds_read_b64_tr_b16 v[238:239], v247 offset:20608
    v_mfma_f32_16x16x32_bf16 v[188:191], v[208:211], v[20:23], v[188:191]
    s_add_u32 s46, s45, 17920
    buffer_load_dwordx4 v[56:59], v245, s[8:11], s46 offen offset:0 sc1
    buffer_load_dwordx4 v[60:63], v245, s[8:11], s46 offen offset:256 sc1
    v_mfma_f32_16x16x32_bf16 v[172:175], v[212:215], v[16:19], v[172:175]
    v_mfma_f32_16x16x32_bf16 v[192:195], v[212:215], v[20:23], v[192:195]
    v_mfma_f32_16x16x32_bf16 v[176:179], v[216:219], v[16:19], v[176:179]
    v_mfma_f32_16x16x32_bf16 v[196:199], v[216:219], v[20:23], v[196:199]
    s_waitcnt vmcnt(8) lgkmcnt(0)
    v_mfma_f32_16x16x32_bf16 v[160:163], v[220:223], v[24:27], v[160:163]
    ds_read_b64_tr_b16 v[200:201], v247 offset:25600
    ds_read_b64_tr_b16 v[202:203], v247 offset:26880
    v_mfma_f32_16x16x32_bf16 v[180:183], v[220:223], v[28:31], v[180:183]
    ds_read_b64_tr_b16 v[204:205], v247 offset:25632
    ds_read_b64_tr_b16 v[206:207], v247 offset:26912
    v_mfma_f32_16x16x32_bf16 v[164:167], v[224:227], v[24:27], v[164:167]
    ds_read_b64_tr_b16 v[208:209], v247 offset:25664
    ds_read_b64_tr_b16 v[210:211], v247 offset:26944
    v_mfma_f32_16x16x32_bf16 v[184:187], v[224:227], v[28:31], v[184:187]
    ds_read_b64_tr_b16 v[212:213], v247 offset:25696
    ds_read_b64_tr_b16 v[214:215], v247 offset:26976
    v_mfma_f32_16x16x32_bf16 v[168:171], v[228:231], v[24:27], v[168:171]
    ds_read_b64_tr_b16 v[216:217], v247 offset:25728
    ds_read_b64_tr_b16 v[218:219], v247 offset:27008
    v_mfma_f32_16x16x32_bf16 v[188:191], v[228:231], v[28:31], v[188:191]
    s_add_u32 s46, s45, 20480
    buffer_load_dwordx4 v[64:67], v245, s[8:11], s46 offen offset:0 sc1
    buffer_load_dwordx4 v[68:71], v245, s[8:11], s46 offen offset:256 sc1
    v_mfma_f32_16x16x32_bf16 v[172:175], v[232:235], v[24:27], v[172:175]
    v_mfma_f32_16x16x32_bf16 v[192:195], v[232:235], v[28:31], v[192:195]
    v_mfma_f32_16x16x32_bf16 v[176:179], v[236:239], v[24:27], v[176:179]
    v_mfma_f32_16x16x32_bf16 v[196:199], v[236:239], v[28:31], v[196:199]
    s_waitcnt vmcnt(8) lgkmcnt(0)
    v_mfma_f32_16x16x32_bf16 v[160:163], v[200:203], v[32:35], v[160:163]
    ds_read_b64_tr_b16 v[220:221], v247 offset:32000
    ds_read_b64_tr_b16 v[222:223], v247 offset:33280
    v_mfma_f32_16x16x32_bf16 v[180:183], v[200:203], v[36:39], v[180:183]
    ds_read_b64_tr_b16 v[224:225], v247 offset:32032
    ds_read_b64_tr_b16 v[226:227], v247 offset:33312
    v_mfma_f32_16x16x32_bf16 v[164:167], v[204:207], v[32:35], v[164:167]
    ds_read_b64_tr_b16 v[228:229], v247 offset:32064
    ds_read_b64_tr_b16 v[230:231], v247 offset:33344
    v_mfma_f32_16x16x32_bf16 v[184:187], v[204:207], v[36:39], v[184:187]
    ds_read_b64_tr_b16 v[232:233], v247 offset:32096
    ds_read_b64_tr_b16 v[234:235], v247 offset:33376
    v_mfma_f32_16x16x32_bf16 v[168:171], v[208:211], v[32:35], v[168:171]
    ds_read_b64_tr_b16 v[236:237], v247 offset:32128
    ds_read_b64_tr_b16 v[238:239], v247 offset:33408
    v_mfma_f32_16x16x32_bf16 v[188:191], v[208:211], v[36:39], v[188:191]
    s_add_u32 s46, s45, 23040
    buffer_load_dwordx4 v[72:75], v245, s[8:11], s46 offen offset:0 sc1
    buffer_load_dwordx4 v[76:79], v245, s[8:11], s46 offen offset:256 sc1
    v_mfma_f32_16x16x32_bf16 v[172:175], v[212:215], v[32:35], v[172:175]
    v_mfma_f32_16x16x32_bf16 v[192:195], v[212:215], v[36:39], v[192:195]
    v_mfma_f32_16x16x32_bf16 v[176:179], v[216:219], v[32:35], v[176:179]
    v_mfma_f32_16x16x32_bf16 v[196:199], v[216:219], v[36:39], v[196:199]
    s_waitcnt vmcnt(8) lgkmcnt(0)
    v_mfma_f32_16x16x32_bf16 v[160:163], v[220:223], v[40:43], v[160:163]
    ds_read_b64_tr_b16 v[200:201], v247 offset:38400
    ds_read_b64_tr_b16 v[202:203], v247 offset:39680
    v_mfma_f32_16x16x32_bf16 v[180:183], v[220:223], v[44:47], v[180:183]
    ds_read_b64_tr_b16 v[204:205], v247 offset:38432
    ds_read_b64_tr_b16 v[206:207], v247 offset:39712
    v_mfma_f32_16x16x32_bf16 v[164:167], v[224:227], v[40:43], v[164:167]
    ds_read_b64_tr_b16 v[208:209], v247 offset:38464
    ds_read_b64_tr_b16 v[210:211], v247 offset:39744
    v_mfma_f32_16x16x32_bf16 v[184:187], v[224:227], v[44:47], v[184:187]
    ds_read_b64_tr_b16 v[212:213], v247 offset:38496
    ds_read_b64_tr_b16 v[214:215], v247 offset:39776
    v_mfma_f32_16x16x32_bf16 v[168:171], v[228:231], v[40:43], v[168:171]
    ds_read_b64_tr_b16 v[216:217], v247 offset:38528
    ds_read_b64_tr_b16 v[218:219], v247 offset:39808
    v_mfma_f32_16x16x32_bf16 v[188:191], v[228:231], v[44:47], v[188:191]
    s_add_u32 s46, s45, 25600
    buffer_load_dwordx4 v[80:83], v245, s[8:11], s46 offen offset:0 sc1
    buffer_load_dwordx4 v[84:87], v245, s[8:11], s46 offen offset:256 sc1
    v_mfma_f32_16x16x32_bf16 v[172:175], v[232:235], v[40:43], v[172:175]
    v_mfma_f32_16x16x32_bf16 v[192:195], v[232:235], v[44:47], v[192:195]
    v_mfma_f32_16x16x32_bf16 v[176:179], v[236:239], v[40:43], v[176:179]
    v_mfma_f32_16x16x32_bf16 v[196:199], v[236:239], v[44:47], v[196:199]
    s_waitcnt vmcnt(8) lgkmcnt(0)
    v_mfma_f32_16x16x32_bf16 v[160:163], v[200:203], v[48:51], v[160:163]
    ds_read_b64_tr_b16 v[220:221], v247 offset:44800
    ds_read_b64_tr_b16 v[222:223], v247 offset:46080
    v_mfma_f32_16x16x32_bf16 v[180:183], v[200:203], v[52:55], v[180:183]
    ds_read_b64_tr_b16 v[224:225], v247 offset:44832
    ds_read_b64_tr_b16 v[226:227], v247 offset:46112
    v_mfma_f32_16x16x32_bf16 v[164:167], v[204:207], v[48:51], v[164:167]
    ds_read_b64_tr_b16 v[228:229], v247 offset:44864
    ds_read_b64_tr_b16 v[230:231], v247 offset:46144
    v_mfma_f32_16x16x32_bf16 v[184:187], v[204:207], v[52:55], v[184:187]
    ds_read_b64_tr_b16 v[232:233], v247 offset:44896
    ds_read_b64_tr_b16 v[234:235], v247 offset:46176
    v_mfma_f32_16x16x32_bf16 v[168:171], v[208:211], v[48:51], v[168:171]
    ds_read_b64_tr_b16 v[236:237], v247 offset:44928
    ds_read_b64_tr_b16 v[238:239], v247 offset:46208
    v_mfma_f32_16x16x32_bf16 v[188:191], v[208:211], v[52:55], v[188:191]
    s_add_u32 s46, s45, 28160
    buffer_load_dwordx4 v[88:91], v245, s[8:11], s46 offen offset:0 sc1
    buffer_load_dwordx4 v[92:95], v245, s[8:11], s46 offen offset:256 sc1
    v_mfma_f32_16x16x32_bf16 v[172:175], v[212:215], v[48:51], v[172:175]
    v_mfma_f32_16x16x32_bf16 v[192:195], v[212:215], v[52:55], v[192:195]
    v_mfma_f32_16x16x32_bf16 v[176:179], v[216:219], v[48:51], v[176:179]
    v_mfma_f32_16x16x32_bf16 v[196:199], v[216:219], v[52:55], v[196:199]
    s_waitcnt vmcnt(8) lgkmcnt(0)
    v_mfma_f32_16x16x32_bf16 v[160:163], v[220:223], v[56:59], v[160:163]
    ds_read_b64_tr_b16 v[200:201], v248 offset:0
    ds_read_b64_tr_b16 v[202:203], v248 offset:1280
    v_mfma_f32_16x16x32_bf16 v[180:183], v[220:223], v[60:63], v[180:183]
    ds_read_b64_tr_b16 v[204:205], v248 offset:32
    ds_read_b64_tr_b16 v[206:207], v248 offset:1312
    v_mfma_f32_16x16x32_bf16 v[164:167], v[224:227], v[56:59], v[164:167]
    ds_read_b64_tr_b16 v[208:209], v248 offset:64
    ds_read_b64_tr_b16 v[210:211], v248 offset:1344
    v_mfma_f32_16x16x32_bf16 v[184:187], v[224:227], v[60:63], v[184:187]
    ds_read_b64_tr_b16 v[212:213], v248 offset:96
    ds_read_b64_tr_b16 v[214:215], v248 offset:1376
    v_mfma_f32_16x16x32_bf16 v[168:171], v[228:231], v[56:59], v[168:171]
    ds_read_b64_tr_b16 v[216:217], v248 offset:128
    ds_read_b64_tr_b16 v[218:219], v248 offset:1408
    v_mfma_f32_16x16x32_bf16 v[188:191], v[228:231], v[60:63], v[188:191]
    s_add_u32 s46, s45, 30720
    buffer_load_dwordx4 v[96:99], v245, s[8:11], s46 offen offset:0 sc1
    buffer_load_dwordx4 v[100:103], v245, s[8:11], s46 offen offset:256 sc1
    v_mfma_f32_16x16x32_bf16 v[172:175], v[232:235], v[56:59], v[172:175]
    v_mfma_f32_16x16x32_bf16 v[192:195], v[232:235], v[60:63], v[192:195]
    v_mfma_f32_16x16x32_bf16 v[176:179], v[236:239], v[56:59], v[176:179]
    v_mfma_f32_16x16x32_bf16 v[196:199], v[236:239], v[60:63], v[196:199]
    s_waitcnt vmcnt(8) lgkmcnt(0)
    v_mfma_f32_16x16x32_bf16 v[160:163], v[200:203], v[64:67], v[160:163]
    ds_read_b64_tr_b16 v[220:221], v248 offset:6400
    ds_read_b64_tr_b16 v[222:223], v248 offset:7680
    v_mfma_f32_16x16x32_bf16 v[180:183], v[200:203], v[68:71], v[180:183]
    ds_read_b64_tr_b16 v[224:225], v248 offset:6432
    ds_read_b64_tr_b16 v[226:227], v248 offset:7712
    v_mfma_f32_16x16x32_bf16 v[164:167], v[204:207], v[64:67], v[164:167]
    ds_read_b64_tr_b16 v[228:229], v248 offset:6464
    ds_read_b64_tr_b16 v[230:231], v248 offset:7744
    v_mfma_f32_16x16x32_bf16 v[184:187], v[204:207], v[68:71], v[184:187]
    ds_read_b64_tr_b16 v[232:233], v248 offset:6496
    ds_read_b64_tr_b16 v[234:235], v248 offset:7776
    v_mfma_f32_16x16x32_bf16 v[168:171], v[208:211], v[64:67], v[168:171]
    ds_read_b64_tr_b16 v[236:237], v248 offset:6528
    ds_read_b64_tr_b16 v[238:239], v248 offset:7808
    v_mfma_f32_16x16x32_bf16 v[188:191], v[208:211], v[68:71], v[188:191]
    s_add_u32 s46, s45, 33280
    buffer_load_dwordx4 v[104:107], v245, s[8:11], s46 offen offset:0 sc1
    buffer_load_dwordx4 v[108:111], v245, s[8:11], s46 offen offset:256 sc1
    v_mfma_f32_16x16x32_bf16 v[172:175], v[212:215], v[64:67], v[172:175]
    v_mfma_f32_16x16x32_bf16 v[192:195], v[212:215], v[68:71], v[192:195]
    v_mfma_f32_16x16x32_bf16 v[176:179], v[216:219], v[64:67], v[176:179]
    v_mfma_f32_16x16x32_bf16 v[196:199], v[216:219], v[68:71], v[196:199]
    s_waitcnt vmcnt(8) lgkmcnt(0)
    v_mfma_f32_16x16x32_bf16 v[160:163], v[220:223], v[72:75], v[160:163]
    ds_read_b64_tr_b16 v[200:201], v248 offset:12800
    ds_read_b64_tr_b16 v[202:203], v248 offset:14080
    v_mfma_f32_16x16x32_bf16 v[180:183], v[220:223], v[76:79], v[180:183]
    ds_read_b64_tr_b16 v[204:205], v248 offset:12832
    ds_read_b64_tr_b16 v[206:207], v248 offset:14112
    v_mfma_f32_16x16x32_bf16 v[164:167], v[224:227], v[72:75], v[164:167]
    ds_read_b64_tr_b16 v[208:209], v248 offset:12864
    ds_read_b64_tr_b16 v[210:211], v248 offset:14144
    v_mfma_f32_16x16x32_bf16 v[184:187], v[224:227], v[76:79], v[184:187]
    ds_read_b64_tr_b16 v[212:213], v248 offset:12896
    ds_read_b64_tr_b16 v[214:215], v248 offset:14176
    v_mfma_f32_16x16x32_bf16 v[168:171], v[228:231], v[72:75], v[168:171]
    ds_read_b64_tr_b16 v[216:217], v248 offset:12928
    ds_read_b64_tr_b16 v[218:219], v248 offset:14208
    v_mfma_f32_16x16x32_bf16 v[188:191], v[228:231], v[76:79], v[188:191]
    s_add_u32 s46, s45, 35840
    buffer_load_dwordx4 v[112:115], v245, s[8:11], s46 offen offset:0 sc1
    buffer_load_dwordx4 v[116:119], v245, s[8:11], s46 offen offset:256 sc1
    v_mfma_f32_16x16x32_bf16 v[172:175], v[232:235], v[72:75], v[172:175]
    v_mfma_f32_16x16x32_bf16 v[192:195], v[232:235], v[76:79], v[192:195]
    v_mfma_f32_16x16x32_bf16 v[176:179], v[236:239], v[72:75], v[176:179]
    v_mfma_f32_16x16x32_bf16 v[196:199], v[236:239], v[76:79], v[196:199]
    s_waitcnt vmcnt(8) lgkmcnt(0)
    v_mfma_f32_16x16x32_bf16 v[160:163], v[200:203], v[80:83], v[160:163]
    ds_read_b64_tr_b16 v[220:221], v248 offset:19200
    ds_read_b64_tr_b16 v[222:223], v248 offset:20480
    v_mfma_f32_16x16x32_bf16 v[180:183], v[200:203], v[84:87], v[180:183]
    ds_read_b64_tr_b16 v[224:225], v248 offset:19232
    ds_read_b64_tr_b16 v[226:227], v248 offset:20512
    v_mfma_f32_16x16x32_bf16 v[164:167], v[204:207], v[80:83], v[164:167]
    ds_read_b64_tr_b16 v[228:229], v248 offset:19264
    ds_read_b64_tr_b16 v[230:231], v248 offset:20544
    v_mfma_f32_16x16x32_bf16 v[184:187], v[204:207], v[84:87], v[184:187]
    ds_read_b64_tr_b16 v[232:233], v248 offset:19296
    ds_read_b64_tr_b16 v[234:235], v248 offset:20576
    v_mfma_f32_16x16x32_bf16 v[168:171], v[208:211], v[80:83], v[168:171]
    ds_read_b64_tr_b16 v[236:237], v248 offset:19328
    ds_read_b64_tr_b16 v[238:239], v248 offset:20608
    v_mfma_f32_16x16x32_bf16 v[188:191], v[208:211], v[84:87], v[188:191]
    s_add_u32 s46, s45, 38400
    buffer_load_dwordx4 v[120:123], v245, s[8:11], s46 offen offset:0 sc1
    buffer_load_dwordx4 v[124:127], v245, s[8:11], s46 offen offset:256 sc1
    v_mfma_f32_16x16x32_bf16 v[172:175], v[212:215], v[80:83], v[172:175]
    v_mfma_f32_16x16x32_bf16 v[192:195], v[212:215], v[84:87], v[192:195]
    v_mfma_f32_16x16x32_bf16 v[176:179], v[216:219], v[80:83], v[176:179]
    v_mfma_f32_16x16x32_bf16 v[196:199], v[216:219], v[84:87], v[196:199]
    s_waitcnt vmcnt(8) lgkmcnt(0)
    v_mfma_f32_16x16x32_bf16 v[160:163], v[220:223], v[88:91], v[160:163]
    ds_read_b64_tr_b16 v[200:201], v248 offset:25600
    ds_read_b64_tr_b16 v[202:203], v248 offset:26880
    v_mfma_f32_16x16x32_bf16 v[180:183], v[220:223], v[92:95], v[180:183]
    ds_read_b64_tr_b16 v[204:205], v248 offset:25632
    ds_read_b64_tr_b16 v[206:207], v248 offset:26912
    v_mfma_f32_16x16x32_bf16 v[164:167], v[224:227], v[88:91], v[164:167]
    ds_read_b64_tr_b16 v[208:209], v248 offset:25664
    ds_read_b64_tr_b16 v[210:211], v248 offset:26944
    v_mfma_f32_16x16x32_bf16 v[184:187], v[224:227], v[92:95], v[184:187]
    ds_read_b64_tr_b16 v[212:213], v248 offset:25696
    ds_read_b64_tr_b16 v[214:215], v248 offset:26976
    v_mfma_f32_16x16x32_bf16 v[168:171], v[228:231], v[88:91], v[168:171]
    ds_read_b64_tr_b16 v[216:217], v248 offset:25728
    ds_read_b64_tr_b16 v[218:219], v248 offset:27008
    v_mfma_f32_16x16x32_bf16 v[188:191], v[228:231], v[92:95], v[188:191]
    s_add_u32 s46, s45, 0
    buffer_load_dwordx2 v[128:129], v246, s[8:11], s46 offen offset:0 sc1
    buffer_load_dwordx2 v[132:133], v246, s[8:11], s46 offen offset:128 sc1
    s_add_u32 s46, s45, 5120
    buffer_load_dwordx2 v[130:131], v246, s[8:11], s46 offen offset:0 sc1
    buffer_load_dwordx2 v[134:135], v246, s[8:11], s46 offen offset:128 sc1
    v_mfma_f32_16x16x32_bf16 v[172:175], v[232:235], v[88:91], v[172:175]
    v_mfma_f32_16x16x32_bf16 v[192:195], v[232:235], v[92:95], v[192:195]
    v_mfma_f32_16x16x32_bf16 v[176:179], v[236:239], v[88:91], v[176:179]
    v_mfma_f32_16x16x32_bf16 v[196:199], v[236:239], v[92:95], v[196:199]
    s_waitcnt vmcnt(10) lgkmcnt(0)
    v_mfma_f32_16x16x32_bf16 v[160:163], v[200:203], v[96:99], v[160:163]
    ds_read_b64_tr_b16 v[220:221], v248 offset:32000
    ds_read_b64_tr_b16 v[222:223], v248 offset:33280
    v_mfma_f32_16x16x32_bf16 v[180:183], v[200:203], v[100:103], v[180:183]
    ds_read_b64_tr_b16 v[224:225], v248 offset:32032
    ds_read_b64_tr_b16 v[226:227], v248 offset:33312
    v_mfma_f32_16x16x32_bf16 v[164:167], v[204:207], v[96:99], v[164:167]
    ds_read_b64_tr_b16 v[228:229], v248 offset:32064
    ds_read_b64_tr_b16 v[230:231], v248 offset:33344
    v_mfma_f32_16x16x32_bf16 v[184:187], v[204:207], v[100:103], v[184:187]
    ds_read_b64_tr_b16 v[232:233], v248 offset:32096
    ds_read_b64_tr_b16 v[234:235], v248 offset:33376
    v_mfma_f32_16x16x32_bf16 v[168:171], v[208:211], v[96:99], v[168:171]
    ds_read_b64_tr_b16 v[236:237], v248 offset:32128
    ds_read_b64_tr_b16 v[238:239], v248 offset:33408
    v_mfma_f32_16x16x32_bf16 v[188:191], v[208:211], v[100:103], v[188:191]
    s_add_u32 s46, s45, 10240
    buffer_load_dwordx2 v[136:137], v246, s[8:11], s46 offen offset:0 sc1
    buffer_load_dwordx2 v[140:141], v246, s[8:11], s46 offen offset:128 sc1
    s_add_u32 s46, s45, 15360
    buffer_load_dwordx2 v[138:139], v246, s[8:11], s46 offen offset:0 sc1
    buffer_load_dwordx2 v[142:143], v246, s[8:11], s46 offen offset:128 sc1
    v_mfma_f32_16x16x32_bf16 v[172:175], v[212:215], v[96:99], v[172:175]
    v_mfma_f32_16x16x32_bf16 v[192:195], v[212:215], v[100:103], v[192:195]
    v_mfma_f32_16x16x32_bf16 v[176:179], v[216:219], v[96:99], v[176:179]
    v_mfma_f32_16x16x32_bf16 v[196:199], v[216:219], v[100:103], v[196:199]
    s_waitcnt vmcnt(12) lgkmcnt(0)
    v_mfma_f32_16x16x32_bf16 v[160:163], v[220:223], v[104:107], v[160:163]
    ds_read_b64_tr_b16 v[200:201], v248 offset:38400
    ds_read_b64_tr_b16 v[202:203], v248 offset:39680
    v_mfma_f32_16x16x32_bf16 v[180:183], v[220:223], v[108:111], v[180:183]
    ds_read_b64_tr_b16 v[204:205], v248 offset:38432
    ds_read_b64_tr_b16 v[206:207], v248 offset:39712
    v_mfma_f32_16x16x32_bf16 v[164:167], v[224:227], v[104:107], v[164:167]
    ds_read_b64_tr_b16 v[208:209], v248 offset:38464
    ds_read_b64_tr_b16 v[210:211], v248 offset:39744
    v_mfma_f32_16x16x32_bf16 v[184:187], v[224:227], v[108:111], v[184:187]
    ds_read_b64_tr_b16 v[212:213], v248 offset:38496
    ds_read_b64_tr_b16 v[214:215], v248 offset:39776
    v_mfma_f32_16x16x32_bf16 v[168:171], v[228:231], v[104:107], v[168:171]
    ds_read_b64_tr_b16 v[216:217], v248 offset:38528
    ds_read_b64_tr_b16 v[218:219], v248 offset:39808
    v_mfma_f32_16x16x32_bf16 v[188:191], v[228:231], v[108:111], v[188:191]
    s_add_u32 s46, s45, 20480
    buffer_load_dwordx2 v[144:145], v246, s[8:11], s46 offen offset:0 sc1
    buffer_load_dwordx2 v[148:149], v246, s[8:11], s46 offen offset:128 sc1
    s_add_u32 s46, s45, 25600
    buffer_load_dwordx2 v[146:147], v246, s[8:11], s46 offen offset:0 sc1
    buffer_load_dwordx2 v[150:151], v246, s[8:11], s46 offen offset:128 sc1
    v_mfma_f32_16x16x32_bf16 v[172:175], v[232:235], v[104:107], v[172:175]
    v_mfma_f32_16x16x32_bf16 v[192:195], v[232:235], v[108:111], v[192:195]
    v_mfma_f32_16x16x32_bf16 v[176:179], v[236:239], v[104:107], v[176:179]
    v_mfma_f32_16x16x32_bf16 v[196:199], v[236:239], v[108:111], v[196:199]
    s_waitcnt vmcnt(14) lgkmcnt(0)
    v_mfma_f32_16x16x32_bf16 v[160:163], v[200:203], v[112:115], v[160:163]
    ds_read_b64_tr_b16 v[220:221], v248 offset:44800
    ds_read_b64_tr_b16 v[222:223], v248 offset:46080
    v_mfma_f32_16x16x32_bf16 v[180:183], v[200:203], v[116:119], v[180:183]
    ds_read_b64_tr_b16 v[224:225], v248 offset:44832
    ds_read_b64_tr_b16 v[226:227], v248 offset:46112
    v_mfma_f32_16x16x32_bf16 v[164:167], v[204:207], v[112:115], v[164:167]
    ds_read_b64_tr_b16 v[228:229], v248 offset:44864
    ds_read_b64_tr_b16 v[230:231], v248 offset:46144
    v_mfma_f32_16x16x32_bf16 v[184:187], v[204:207], v[116:119], v[184:187]
    ds_read_b64_tr_b16 v[232:233], v248 offset:44896
    ds_read_b64_tr_b16 v[234:235], v248 offset:46176
    v_mfma_f32_16x16x32_bf16 v[168:171], v[208:211], v[112:115], v[168:171]
    ds_read_b64_tr_b16 v[236:237], v248 offset:44928
    ds_read_b64_tr_b16 v[238:239], v248 offset:46208
    v_mfma_f32_16x16x32_bf16 v[188:191], v[208:211], v[116:119], v[188:191]
    s_add_u32 s46, s45, 30720
    buffer_load_dwordx2 v[152:153], v246, s[8:11], s46 offen offset:0 sc1
    buffer_load_dwordx2 v[156:157], v246, s[8:11], s46 offen offset:128 sc1
    s_add_u32 s46, s45, 35840
    buffer_load_dwordx2 v[154:155], v246, s[8:11], s46 offen offset:0 sc1
    buffer_load_dwordx2 v[158:159], v246, s[8:11], s46 offen offset:128 sc1
    v_mfma_f32_16x16x32_bf16 v[172:175], v[212:215], v[112:115], v[172:175]
    v_mfma_f32_16x16x32_bf16 v[192:195], v[212:215], v[116:119], v[192:195]
    v_mfma_f32_16x16x32_bf16 v[176:179], v[216:219], v[112:115], v[176:179]
    v_mfma_f32_16x16x32_bf16 v[196:199], v[216:219], v[116:119], v[196:199]
    s_waitcnt vmcnt(16) lgkmcnt(0)
    v_mfma_f32_16x16x32_bf16 v[160:163], v[220:223], v[120:123], v[160:163]
    ds_read_b64_tr_b16 v[200:201], v249 offset:0
    ds_read_b64_tr_b16 v[202:203], v249 offset:12800
    v_mfma_f32_16x16x32_bf16 v[180:183], v[220:223], v[124:127], v[180:183]
    ds_read_b64_tr_b16 v[204:205], v249 offset:32
    ds_read_b64_tr_b16 v[206:207], v249 offset:12832
    v_mfma_f32_16x16x32_bf16 v[164:167], v[224:227], v[120:123], v[164:167]
    ds_read_b64_tr_b16 v[208:209], v249 offset:64
    ds_read_b64_tr_b16 v[210:211], v249 offset:12864
    v_mfma_f32_16x16x32_bf16 v[184:187], v[224:227], v[124:127], v[184:187]
    ds_read_b64_tr_b16 v[212:213], v249 offset:96
    ds_read_b64_tr_b16 v[214:215], v249 offset:12896
    v_mfma_f32_16x16x32_bf16 v[168:171], v[228:231], v[120:123], v[168:171]
    ds_read_b64_tr_b16 v[216:217], v249 offset:128
    ds_read_b64_tr_b16 v[218:219], v249 offset:12928
    v_mfma_f32_16x16x32_bf16 v[188:191], v[228:231], v[124:127], v[188:191]
    v_mfma_f32_16x16x32_bf16 v[172:175], v[232:235], v[120:123], v[172:175]
    v_mfma_f32_16x16x32_bf16 v[192:195], v[232:235], v[124:127], v[192:195]
    v_mfma_f32_16x16x32_bf16 v[176:179], v[236:239], v[120:123], v[176:179]
    v_mfma_f32_16x16x32_bf16 v[196:199], v[236:239], v[124:127], v[196:199]
    s_waitcnt vmcnt(12) lgkmcnt(0)
    v_mfma_f32_16x16x32_bf16 v[160:163], v[200:203], v[128:131], v[160:163]
    ds_read_b64_tr_b16 v[220:221], v249 offset:25600
    ds_read_b64_tr_b16 v[222:223], v249 offset:38400
    v_mfma_f32_16x16x32_bf16 v[180:183], v[200:203], v[132:135], v[180:183]
    ds_read_b64_tr_b16 v[224:225], v249 offset:25632
    ds_read_b64_tr_b16 v[226:227], v249 offset:38432
    v_mfma_f32_16x16x32_bf16 v[164:167], v[204:207], v[128:131], v[164:167]
    ds_read_b64_tr_b16 v[228:229], v249 offset:25664
    ds_read_b64_tr_b16 v[230:231], v249 offset:38464
    v_mfma_f32_16x16x32_bf16 v[184:187], v[204:207], v[132:135], v[184:187]
    ds_read_b64_tr_b16 v[232:233], v249 offset:25696
    ds_read_b64_tr_b16 v[234:235], v249 offset:38496
    v_mfma_f32_16x16x32_bf16 v[168:171], v[208:211], v[128:131], v[168:171]
    ds_read_b64_tr_b16 v[236:237], v249 offset:25728
    ds_read_b64_tr_b16 v[238:239], v249 offset:38528
    v_mfma_f32_16x16x32_bf16 v[188:191], v[208:211], v[132:135], v[188:191]
    v_mfma_f32_16x16x32_bf16 v[172:175], v[212:215], v[128:131], v[172:175]
    v_mfma_f32_16x16x32_bf16 v[192:195], v[212:215], v[132:135], v[192:195]
    v_mfma_f32_16x16x32_bf16 v[176:179], v[216:219], v[128:131], v[176:179]
    v_mfma_f32_16x16x32_bf16 v[196:199], v[216:219], v[132:135], v[196:199]
    s_waitcnt vmcnt(8) lgkmcnt(0)
    v_mfma_f32_16x16x32_bf16 v[160:163], v[220:223], v[136:139], v[160:163]
    ds_read_b64_tr_b16 v[200:201], v250 offset:0
    ds_read_b64_tr_b16 v[202:203], v250 offset:12800
    v_mfma_f32_16x16x32_bf16 v[180:183], v[220:223], v[140:143], v[180:183]
    ds_read_b64_tr_b16 v[204:205], v250 offset:32
    ds_read_b64_tr_b16 v[206:207], v250 offset:12832
    v_mfma_f32_16x16x32_bf16 v[164:167], v[224:227], v[136:139], v[164:167]
    ds_read_b64_tr_b16 v[208:209], v250 offset:64
    ds_read_b64_tr_b16 v[210:211], v250 offset:12864
    v_mfma_f32_16x16x32_bf16 v[184:187], v[224:227], v[140:143], v[184:187]
    ds_read_b64_tr_b16 v[212:213], v250 offset:96
    ds_read_b64_tr_b16 v[214:215], v250 offset:12896
    v_mfma_f32_16x16x32_bf16 v[168:171], v[228:231], v[136:139], v[168:171]
    ds_read_b64_tr_b16 v[216:217], v250 offset:128
    ds_read_b64_tr_b16 v[218:219], v250 offset:12928
    v_mfma_f32_16x16x32_bf16 v[188:191], v[228:231], v[140:143], v[188:191]
    v_mfma_f32_16x16x32_bf16 v[172:175], v[232:235], v[136:139], v[172:175]
    v_mfma_f32_16x16x32_bf16 v[192:195], v[232:235], v[140:143], v[192:195]
    v_mfma_f32_16x16x32_bf16 v[176:179], v[236:239], v[136:139], v[176:179]
    v_mfma_f32_16x16x32_bf16 v[196:199], v[236:239], v[140:143], v[196:199]
    s_waitcnt vmcnt(4) lgkmcnt(0)
    v_mfma_f32_16x16x32_bf16 v[160:163], v[200:203], v[144:147], v[160:163]
    ds_read_b64_tr_b16 v[220:221], v250 offset:25600
    ds_read_b64_tr_b16 v[222:223], v250 offset:38400
    v_mfma_f32_16x16x32_bf16 v[180:183], v[200:203], v[148:151], v[180:183]
    ds_read_b64_tr_b16 v[224:225], v250 offset:25632
    ds_read_b64_tr_b16 v[226:227], v250 offset:38432
    v_mfma_f32_16x16x32_bf16 v[164:167], v[204:207], v[144:147], v[164:167]
    ds_read_b64_tr_b16 v[228:229], v250 offset:25664
    ds_read_b64_tr_b16 v[230:231], v250 offset:38464
    v_mfma_f32_16x16x32_bf16 v[184:187], v[204:207], v[148:151], v[184:187]
    ds_read_b64_tr_b16 v[232:233], v250 offset:25696
    ds_read_b64_tr_b16 v[234:235], v250 offset:38496
    v_mfma_f32_16x16x32_bf16 v[168:171], v[208:211], v[144:147], v[168:171]
    ds_read_b64_tr_b16 v[236:237], v250 offset:25728
    ds_read_b64_tr_b16 v[238:239], v250 offset:38528
    v_mfma_f32_16x16x32_bf16 v[188:191], v[208:211], v[148:151], v[188:191]
    v_mfma_f32_16x16x32_bf16 v[172:175], v[212:215], v[144:147], v[172:175]
    v_mfma_f32_16x16x32_bf16 v[192:195], v[212:215], v[148:151], v[192:195]
    v_mfma_f32_16x16x32_bf16 v[176:179], v[216:219], v[144:147], v[176:179]
    v_mfma_f32_16x16x32_bf16 v[196:199], v[216:219], v[148:151], v[196:199]
    s_waitcnt vmcnt(0) lgkmcnt(0)
    v_mfma_f32_16x16x32_bf16 v[160:163], v[220:223], v[152:155], v[160:163]
    v_mfma_f32_16x16x32_bf16 v[180:183], v[220:223], v[156:159], v[180:183]
    v_mfma_f32_16x16x32_bf16 v[164:167], v[224:227], v[152:155], v[164:167]
    v_mfma_f32_16x16x32_bf16 v[184:187], v[224:227], v[156:159], v[184:187]
    v_mfma_f32_16x16x32_bf16 v[168:171], v[228:231], v[152:155], v[168:171]
    v_mfma_f32_16x16x32_bf16 v[188:191], v[228:231], v[156:159], v[188:191]
    v_mfma_f32_16x16x32_bf16 v[172:175], v[232:235], v[152:155], v[172:175]
    v_mfma_f32_16x16x32_bf16 v[192:195], v[232:235], v[156:159], v[192:195]
    v_mfma_f32_16x16x32_bf16 v[176:179], v[236:239], v[152:155], v[176:179]
    v_mfma_f32_16x16x32_bf16 v[196:199], v[236:239], v[156:159], v[196:199]
    v_and_b32 v253, 15, v251
    v_mul_u32_u24 v253, 160, v253
    v_lshrrev_b32 v252, 4, v251
    v_lshl_add_u32 v253, v252, 3, v253
    s_mul_i32 s18, s3, 5120
    s_add_u32 s18, s18, 102400
    v_add_u32 v253, s18, v253
    v_lshlrev_b32 v254, 4, v251
    v_add_u32 v254, s18, v254
    s_nop 3
    v_cvt_pk_bf16_f32 v0, v160, v161
    v_cvt_pk_bf16_f32 v1, v162, v163
    ds_write_b64 v253, v[0:1] offset:0
    v_cvt_pk_bf16_f32 v2, v164, v165
    v_cvt_pk_bf16_f32 v3, v166, v167
    ds_write_b64 v253, v[2:3] offset:32
    v_cvt_pk_bf16_f32 v4, v168, v169
    v_cvt_pk_bf16_f32 v5, v170, v171
    ds_write_b64 v253, v[4:5] offset:64
    v_cvt_pk_bf16_f32 v6, v172, v173
    v_cvt_pk_bf16_f32 v7, v174, v175
    ds_write_b64 v253, v[6:7] offset:96
    v_cvt_pk_bf16_f32 v8, v176, v177
    v_cvt_pk_bf16_f32 v9, v178, v179
    ds_write_b64 v253, v[8:9] offset:128
    v_cvt_pk_bf16_f32 v10, v180, v181
    v_cvt_pk_bf16_f32 v11, v182, v183
    ds_write_b64 v253, v[10:11] offset:2560
    v_cvt_pk_bf16_f32 v12, v184, v185
    v_cvt_pk_bf16_f32 v13, v186, v187
    ds_write_b64 v253, v[12:13] offset:2592
    v_cvt_pk_bf16_f32 v14, v188, v189
    v_cvt_pk_bf16_f32 v15, v190, v191
    ds_write_b64 v253, v[14:15] offset:2624
    v_cvt_pk_bf16_f32 v16, v192, v193
    v_cvt_pk_bf16_f32 v17, v194, v195
    ds_write_b64 v253, v[16:17] offset:2656
    v_cvt_pk_bf16_f32 v18, v196, v197
    v_cvt_pk_bf16_f32 v19, v198, v199
    ds_write_b64 v253, v[18:19] offset:2688
    s_movk_i32 s20, 6554
    s_movk_i32 s21, 2560
    v_add_u32 v252, 0, v251
    v_mul_lo_u32 v247, v252, s20
    v_lshrrev_b32 v247, 16, v247
    v_mul_u32_u24 v249, 10, v247
    v_sub_u32 v252, v252, v249
    v_lshlrev_b32 v252, 4, v252
    v_mad_u32_u24 v240, v247, s21, v252
    v_add_u32 v252, 64, v251
    v_mul_lo_u32 v247, v252, s20
    v_lshrrev_b32 v247, 16, v247
    v_mul_u32_u24 v249, 10, v247
    v_sub_u32 v252, v252, v249
    v_lshlrev_b32 v252, 4, v252
    v_mad_u32_u24 v241, v247, s21, v252
    v_add_u32 v252, 128, v251
    v_mul_lo_u32 v247, v252, s20
    v_lshrrev_b32 v247, 16, v247
    v_mul_u32_u24 v249, 10, v247
    v_sub_u32 v252, v252, v249
    v_lshlrev_b32 v252, 4, v252
    v_mad_u32_u24 v242, v247, s21, v252
    v_add_u32 v252, 192, v251
    v_mul_lo_u32 v247, v252, s20
    v_lshrrev_b32 v247, 16, v247
    v_mul_u32_u24 v249, 10, v247
    v_sub_u32 v252, v252, v249
    v_lshlrev_b32 v252, 4, v252
    v_mad_u32_u24 v243, v247, s21, v252
    v_add_u32 v252, 256, v251
    v_mul_lo_u32 v247, v252, s20
    v_lshrrev_b32 v247, 16, v247
    v_mul_u32_u24 v249, 10, v247
    v_sub_u32 v252, v252, v249
    v_lshlrev_b32 v252, 4, v252
    v_mad_u32_u24 v244, v247, s21, v252
    s_mul_i32 s18, s44, 81920
    s_mul_i32 s19, s64, 1280
    s_add_u32 s18, s18, s19
    s_mul_i32 s19, s66, 160
    s_add_u32 s18, s18, s19
    s_waitcnt lgkmcnt(0)
    ds_read_b128 v[32:35], v254 offset:0
    ds_read_b128 v[36:39], v254 offset:1024
    ds_read_b128 v[40:43], v254 offset:2048
    ds_read_b128 v[44:47], v254 offset:3072
    ds_read_b128 v[48:51], v254 offset:4096
    s_waitcnt lgkmcnt(4)
    buffer_store_dwordx4 v[32:35], v240, s[28:31], s18 offen nt
    s_waitcnt lgkmcnt(3)
    buffer_store_dwordx4 v[36:39], v241, s[28:31], s18 offen nt
    s_waitcnt lgkmcnt(2)
    buffer_store_dwordx4 v[40:43], v242, s[28:31], s18 offen nt
    s_waitcnt lgkmcnt(1)
    buffer_store_dwordx4 v[44:47], v243, s[28:31], s18 offen nt
    s_waitcnt lgkmcnt(0)
    buffer_store_dwordx4 v[48:51], v244, s[28:31], s18 offen nt
concat_heads__linear_attn_block__sliding_block__prompt_kernel_fin:
concat_heads__linear_attn_block__sliding_block__prompt_kernel_end:
    s_endpgm
.section .rodata,"a"
.p2align 6
.amdhsa_kernel concat_heads__linear_attn_block__sliding_block__prompt_kernel
    .amdhsa_next_free_vgpr 256
    .amdhsa_next_free_sgpr 100
    .amdhsa_accum_offset 256
    .amdhsa_group_segment_fixed_size 0
    .amdhsa_kernarg_size 72
    .amdhsa_user_sgpr_count 2
    .amdhsa_user_sgpr_kernarg_segment_ptr 1
    .amdhsa_system_sgpr_workgroup_id_x 1
    .amdhsa_float_denorm_mode_32 3
    .amdhsa_float_denorm_mode_16_64 3
.end_amdhsa_kernel
```
